```python
import torch

def _softmax(x, axis=-1):
    return torch.softmax(x, dim=axis)
def _gelu(x):
    return torch.nn.functional.gelu(x, approximate="tanh")
def _silu(x):
    return torch.nn.functional.silu(x)
def _sigmoid(x):
    return torch.sigmoid(x)
def _layernorm(x, axis=-1, eps=1e-5):
    m = x.mean(dim=axis, keepdim=True)
    v = x.var(dim=axis, keepdim=True, unbiased=False)
    return (x - m) / torch.sqrt(v + eps)
def _scatter_add(tgt, idx, src, axis=0):
    return tgt.clone().index_add_(axis, idx, src)
def _segment_sum(src, seg, n):
    out = torch.zeros((n,) + src.shape[1:], dtype=src.dtype)
    return out.index_add_(0, seg, src)
def _pad(x, pw):
    flat = tuple(v for pair in reversed(pw) for v in pair)
    return torch.nn.functional.pad(x, flat)

kernel_name = 'recurrent_scan__spectral_fnet__swiglu_ffn__prompt'

def setup_inputs():

    _w = (lambda a: (lambda t: t.to(torch.bfloat16) if t.is_floating_point() else t)(torch.as_tensor(a)))
    def _A_setup():
        B, S, D = 1, 2048, 512
        ns = torch.arange(S)[:, None] * torch.arange(S)[None, :]
        nd = torch.arange(D)[:, None] * torch.arange(D)[None, :]
        Ws_re = torch.cos(-2.0 * torch.pi * ns / S).to(float)
        Ws_im = torch.sin(-2.0 * torch.pi * ns / S).to(float)
        Wd_re = torch.cos(-2.0 * torch.pi * nd / D).to(float)
        Wd_im = torch.sin(-2.0 * torch.pi * nd / D).to(float)
        return {
            "x": _w((lambda *s: torch.randn(*s, dtype=torch.bfloat16) * 0.05)(B, S, D)),
            "dft_seq_re": _w(Ws_re),
            "dft_seq_im": _w(Ws_im),
            "dft_hid_re": _w(Wd_re),
            "dft_hid_im": _w(Wd_im),
        }
    _A_in = _A_setup()

    def _B_setup():
        B, S, D, F = 1, 2048, 512, 1792
        return {
            "x": _w((lambda *s: torch.randn(*s, dtype=torch.bfloat16) * 0.05)(B, S, D)),
            "w_gate": _w((lambda *s: torch.randn(*s, dtype=torch.bfloat16) * 0.05)(D, F)),
            "w_up": _w((lambda *s: torch.randn(*s, dtype=torch.bfloat16) * 0.05)(D, F)),
            "w_down": _w((lambda *s: torch.randn(*s, dtype=torch.bfloat16) * 0.05)(F, D)),
        }
    _B_in = _B_setup()

    return {
        "A_x": _A_in["x"],
        "A_dft_seq_re": _A_in["dft_seq_re"],
        "A_dft_seq_im": _A_in["dft_seq_im"],
        "A_dft_hid_re": _A_in["dft_hid_re"],
        "A_dft_hid_im": _A_in["dft_hid_im"],
        "B_x": _B_in["x"],
        "B_w_gate": _B_in["w_gate"],
        "B_w_up": _B_in["w_up"],
        "B_w_down": _B_in["w_down"],
    }

def reference(A_x, A_dft_seq_re, A_dft_seq_im, A_dft_hid_re, A_dft_hid_im, B_x, B_w_gate, B_w_up, B_w_down):
    def _A_ref(x, dft_seq_re, dft_seq_im, dft_hid_re, dft_hid_im):
        a = torch.einsum("bsd,ed->bse", x, dft_hid_re)
        b = torch.einsum("bsd,ed->bse", x, dft_hid_im)
        y = torch.einsum("ts,bse->bte", dft_seq_re, a) - torch.einsum("ts,bse->bte", dft_seq_im, b)
        return y

    def _B_ref(x, w_gate, w_up, w_down):
        g = _silu(x @ w_gate)
        u = x @ w_up
        return (g * u) @ w_down

    x = A_x
    xn = _layernorm(x, axis=-1)
    s = _A_ref(xn, A_dft_seq_re, A_dft_seq_im, A_dft_hid_re, A_dft_hid_im)
    g = _silu(_B_ref(xn, B_w_gate, B_w_up, B_w_down))
    return x + s * g
```

```asm
; @launch grid=(256,1,1) block=(256,1,1) lds=163840
.amdgcn_target "amdgcn-amd-amdhsa--gfx950"
.text
.globl recurrent_scan__spectral_fnet__swiglu_ffn__prompt_kernel
.p2align 12
.p2align 8
.type recurrent_scan__spectral_fnet__swiglu_ffn__prompt_kernel,@function
recurrent_scan__spectral_fnet__swiglu_ffn__prompt_kernel:
    s_cmpk_ge_u32 s2, 256
    s_cbranch_scc1 k_end
    s_load_dwordx2 s[8:9], s[0:1], 0
    s_load_dwordx4 s[56:59], s[0:1], 24
    s_load_dwordx4 s[4:7], s[0:1], 48
    v_lshrrev_b32 v1, 6, v0
    v_and_b32 v0, 63, v0
    s_getpc_b64 s[52:53]
k_pc:
    s_lshr_b32 s51, s2, 3
    v_readfirstlane_b32 s38, v1
    s_lshr_b32 s36, s2, 5
    s_lshl2_add_u32 s51, s51, s38
    s_mulk_i32 s51, 3
    v_add_lshl_u32 v2, s51, v0, 1
    v_mad_u64_u32 v[2:3], vcc, v2, 64, s[52:53]
    s_mov_b64 exec, 7
    global_load_dword v254, v[2:3], off
    s_mov_b64 exec, -1
    s_and_b32 s52, s2, 1
    s_lshr_b32 s40, s36, 2
    s_lshl1_add_u32 s40, s40, s52
    s_lshl_b32 s40, s40, 2
    s_lshl1_add_u32 s36, s36, s52
    s_bfe_u32 s51, s2, 0x20003
    s_and_b32 s52, s2, 6
    s_lshl1_add_u32 s52, s52, s51
    s_mov_b32 s37, s52
    s_mov_b32 s11, 0x20000
    s_lshl_b32 s10, s11, 4
    v_lshlrev_b32 v26, 4, v0
    s_lshl_b32 s43, s38, 12
    s_and_b32 s51, s37, 1
    s_movk_i32 s39, 1024
    s_cmp_lt_u32 s37, 14
    s_cselect_b32 s51, s37, s51
    s_cmovk_i32 s39, 3584
    v_lshrrev_b32 v2, 4, v0
    v_and_b32 v6, 2, v1
    v_lshl_or_b32 v6, v6, 1, v2
    v_lshlrev_b32 v6, 1, v6
    v_xor_b32 v6, v6, v0
    v_and_b32 v6, 15, v6
    v_lshl_or_b32 v6, s51, 4, v6
    v_lshlrev_b32 v6, 4, v6
    v_lshl_add_u32 v2, v1, 2, v2
    v_mad_u32_u24 v8, v2, s39, v6
    s_mov_b32 s15, s11
    s_mov_b32 s19, s11
    s_lshl_b32 s51, s39, 4
    s_addk_i32 s51, -2048
    v_add_u32 v9, s51, v8
    s_lshl_b32 s14, s39, 9
    s_movk_i32 s51, 1024
    s_add_u32 s18, s14, s51
    s_lshl_b32 s42, s39, 5
    s_add_u32 m0, s43, 0
    s_xor_b32 s44, s40, 0
    s_mul_i32 s44, s44, s42
    s_cmp_lt_u32 s37, 14
    s_waitcnt lgkmcnt(0)
    s_cselect_b64 s[12:13], s[4:5], s[56:57]
    s_cselect_b64 s[16:17], s[6:7], s[58:59]
    buffer_load_dwordx4 v8, s[12:15], s44 offen offset:0 lds
    s_sub_u32 s16, s16, s51
    s_subb_u32 s17, s17, 0
    buffer_load_dwordx4 v8, s[16:19], s44 offen offset:1024 lds
    buffer_load_dwordx4 v9, s[12:15], s44 offen offset:2048 lds
    buffer_load_dwordx4 v9, s[16:19], s44 offen offset:3072 lds
    v_lshrrev_b32 v2, 3, v0
    v_lshl_add_u32 v2, v1, 3, v2
    v_lshlrev_b32 v6, 3, v2
    v_xor_b32 v6, v6, v26
    s_movk_i32 s51, 112
    v_and_b32 v6, s51, v6
    v_lshl_add_u32 v6, v2, 16, v6
    s_cmp_eq_u32 s36, 0
    s_cselect_b32 s54, 16, s36
    s_cselect_b32 s55, 32, s36
    s_sub_u32 s53, 31, s54
    s_add_u32 s54, 30, s54
    s_sub_u32 s55, 61, s55
    v_lshl_add_u32 v10, s36, 10, v6
    v_lshl_add_u32 v11, s53, 10, v6
    v_lshl_add_u32 v12, s54, 10, v6
    v_lshl_add_u32 v13, s55, 10, v6
    s_lshr_b32 s41, s40, 1
    s_lshl_b32 s41, s41, 7
    s_add_u32 m0, s43, 65536
    s_xor_b32 s45, s41, 0
    buffer_load_dwordx4 v10, s[8:11], s45 offen offset:0 lds
    buffer_load_dwordx4 v11, s[8:11], s45 offen offset:1024 lds
    buffer_load_dwordx4 v12, s[8:11], s45 offen offset:2048 lds
    buffer_load_dwordx4 v13, s[8:11], s45 offen offset:3072 lds
    s_load_dwordx2 s[20:21], s[0:1], 88
    s_load_dwordx2 s[24:25], s[0:1], 64
    s_load_dwordx2 s[28:29], s[0:1], 72
    s_load_dwordx2 s[32:33], s[0:1], 80
    s_and_b32 s52, s37, 3
    s_lshl_b32 s52, s52, 3
    v_lshrrev_b32 v2, 5, v0
    v_lshl_add_u32 v2, v1, 1, v2
    v_add_u32 v5, s52, v2
    v_and_b32 v3, 496, v26
    v_lshl_add_u32 v29, v5, 16, v3
    s_pack_ll_b32_b16 s54, s36, s54
    s_pack_ll_b32_b16 s53, s53, s55
    s_lshl_b32 s53, s53, 8
    s_add_u32 s53, s53, s54
    s_add_u32 s60, s53, 0x03020100
    s_and_b32 s55, s37, 12
    s_lshl_b32 s53, s55, 1
    s_lshr_b32 s53, s60, s53
    s_and_b32 s53, s53, 63
    s_lshl_b32 s61, s53, 10
    s_mov_b32 s22, 9764864
    s_mov_b32 s23, s11
    s_and_b32 s3, s2, 143
    s_cbranch_scc1 k_noreset
    v_mov_b32 v168, -1
    v_mov_b32 v169, -1
    v_mov_b32 v170, -1
    v_mov_b32 v171, -1
    s_lshr_b32 s51, s2, 258
    s_add_u32 s51, s51, s38
    s_mul_i32 s51, s51, 5120
    s_add_u32 s51, s51, 9601024
    s_waitcnt lgkmcnt(0)
    buffer_store_dwordx4 v[168:171], v26, s[20:23], s51 offen offset:0 sc1
    buffer_store_dwordx4 v[168:171], v26, s[20:23], s51 offen offset:1024 sc1
    buffer_store_dwordx4 v[168:171], v26, s[20:23], s51 offen offset:2048 sc1
    buffer_store_dwordx4 v[168:171], v26, s[20:23], s51 offen offset:3072 sc1
    s_addk_i32 s51, 4096
    buffer_store_dwordx4 v[168:171], v26, s[20:23], s51 offen offset:0 sc1
k_noreset:
    v_bfe_u32 v2, v0, 4, 1
    v_bfe_u32 v3, v0, 2, 2
    v_and_b32 v4, 3, v0
    v_lshrrev_b32 v6, 5, v0
    v_lshlrev_b32_e64 v7, 3, v4
    v_lshl_add_u32 v7, v2, 13, v7
    v_lshl_add_u32 v7, v6, 11, v7
    v_lshl_add_u32 v7, v3, 8, v7
    v_lshl_or_b32 v4, v2, 2, v3
    v_lshlrev_b32 v6, 1, v1
    v_xor_b32 v6, v6, v4
    v_lshl_add_u32 v14, v6, 5, v7
    v_xor_b32 v15, 32, v14
    v_bfe_u32 v2, v0, 3, 1
    v_and_b32 v3, 7, v0
    v_lshlrev_b32_e64 v2, 12, v2
    v_lshl_add_u32 v2, v3, 7, v2
    v_add_u32 v2, 65536, v2
    v_bfe_u32 v3, v0, 1, 3
    v_lshrrev_b32 v4, 4, v0
    v_xor_b32 v3, v3, v4
    v_lshl_add_u32 v2, v3, 4, v2
    s_and_b32 s51, s40, 1
    s_lshl_b32 s51, s51, 6
    v_xor_b32 v16, s51, v2
    v_xor_b32 v17, 64, v16
    v_mov_b32 v27, 2147483632
    v_writelane_b32 v27, 0, 0
    s_lshl_b32 s51, s36, 7
    s_lshl3_add_u32 s51, s55, s51
    v_add_lshl_u32 v5, s51, v5, 4
    v_and_b32_e64 v2, 31, v0
    v_lshl_add_u32 v5, v2, 25, v5
    s_mov_b32 s26, 1835008
    s_mov_b32 s27, s11
    s_mov_b32 s34, 256
    s_mov_b32 s35, s11
    s_mov_b32 s63, 0
    s_cmp_ge_u32 s37, 14
    s_cbranch_scc0 k_nomgen
    s_add_u32 s54, s43, 131072
    s_lshl_b32 s53, s38, 3
    s_lshr_b32 s53, s60, s53
    s_and_b32 s53, s53, 63
    v_and_b32 v208, 15, v0
    v_cvt_f32_u32 v210, v208
    v_lshrrev_b32 v209, 4, v0
    v_lshl_add_u32 v209, v209, 8, s53
    v_cvt_f32_u32 v209, v209
    v_mul_f32 v210, 0x3d000000, v210
    v_mul_f32 v209, 0x3c800000, v209
    v_add_u32_e64 v212, s54, v26
    v_bfe_i32 v213, v0, 0, 1
    v_and_b32 v213, 0x80008000, v213
    v_mul_f32 v220, v209, v210
    v_add_f32 v221, v220, v210
    v_add_f32 v222, v221, v210
    v_add_f32 v223, v222, v210
    v_cos_f32 v216, v220
    v_sin_f32 v220, v220
    v_cos_f32 v217, v221
    v_sin_f32 v221, v221
    v_cos_f32 v218, v222
    v_sin_f32 v222, v222
    v_cos_f32 v219, v223
    v_sin_f32 v223, v223
    v_cvt_pk_bf16_f32 v224, v216, v217
    v_cvt_pk_bf16_f32 v225, v218, v219
    v_cvt_pk_bf16_f32 v228, v220, v221
    v_cvt_pk_bf16_f32 v229, v222, v223
    v_xor_b32 v226, v213, v224
    v_xor_b32 v227, v213, v225
    v_xor_b32 v230, v213, v228
    v_xor_b32 v231, v213, v229
    ds_write_b128 v212, v[224:227] offset:0
    ds_write_b128 v212, v[228:231] offset:1024
    v_add_f32 v210, 0.5, v210
    v_mul_f32 v220, v209, v210
    v_add_f32 v221, v220, v210
    v_add_f32 v222, v221, v210
    v_add_f32 v223, v222, v210
    v_cos_f32 v216, v220
    v_sin_f32 v220, v220
    v_cos_f32 v217, v221
    v_sin_f32 v221, v221
    v_cos_f32 v218, v222
    v_sin_f32 v222, v222
    v_cos_f32 v219, v223
    v_sin_f32_e64 v223, v223
    v_cvt_pk_bf16_f32 v232, v216, v217
    v_cvt_pk_bf16_f32 v233, v218, v219
    v_cvt_pk_bf16_f32 v236, v220, v221
    v_cvt_pk_bf16_f32 v237, v222, v223
    v_xor_b32 v234, v213, v232
    v_xor_b32 v235, v213, v233
    v_xor_b32 v238, v213, v236
    v_xor_b32 v239, v213, v237
    ds_write_b128 v212, v[232:235] offset:2048
    ds_write_b128 v212, v[236:239] offset:3072
k_nomgen:
    v_mov_b32 v192, 0x3f803f80
    v_mov_b32 v193, v192
    v_mov_b32 v194, v192
    v_mov_b32 v195, v192
    v_mov_b32 v31, 1
    s_or_b32 s99, s38, s3
k_padA:
    s_mov_b64 exec, 0
    s_cmp_ge_u32 s37, 14
    s_cbranch_scc1 k_padd
    s_cmp_eq_u32 s38, 0
    s_cbranch_scc1 k_pad4
    s_cmp_eq_u32 s38, 1
    s_cbranch_scc1 k_pad5
    s_cmp_eq_u32 s38, 2
    s_cbranch_scc1 k_pad6
    s_branch k_pad3
k_padd:
    s_cmp_eq_u32 s38, 0
    s_cbranch_scc1 k_pad1
    s_cmp_eq_u32 s38, 1
    s_cbranch_scc1 k_pad9
    s_cmp_eq_u32 s38, 2
    s_cbranch_scc1 k_pad10
    s_branch k_pad11
k_padback:
    s_mov_b64 exec, -1
    s_add_u32 m0, s43, 16384
    s_xor_b32 s44, s40, 1
    s_mul_i32 s44, s44, s42
    buffer_load_dwordx4 v8, s[12:15], s44 offen offset:0 lds
    buffer_load_dwordx4 v8, s[16:19], s44 offen offset:1024 lds
    buffer_load_dwordx4 v9, s[12:15], s44 offen offset:2048 lds
    buffer_load_dwordx4 v9, s[16:19], s44 offen offset:3072 lds
    buffer_load_dwordx4 v[160:163], v29, s[8:11], s61 offen
    buffer_load_dwordx4 v[164:167], v29, s[8:11], s61 offen offset:512
    s_add_u32 m0, s43, 81920
    s_xor_b32 s45, s41, 128
    buffer_load_dwordx4 v10, s[8:11], s45 offen offset:0 lds
    buffer_load_dwordx4 v11, s[8:11], s45 offen offset:1024 lds
    s_waitcnt vmcnt(8) lgkmcnt(0)
    s_barrier
    ds_read_b64_tr_b16 a[96:97], v14 offset:0
    ds_read_b64_tr_b16 a[98:99], v14 offset:4096
    ds_read_b64_tr_b16 a[100:101], v15 offset:0
    ds_read_b64_tr_b16 a[102:103], v15 offset:4096
    ds_read_b64_tr_b16 a[104:105], v14 offset:1024
    ds_read_b64_tr_b16 a[106:107], v14 offset:5120
    ds_read_b64_tr_b16 a[108:109], v15 offset:1024
    ds_read_b64_tr_b16 a[110:111], v15 offset:5120
    ds_read_b128 a[64:67], v16 offset:0
    ds_read_b128 a[68:71], v16 offset:8192
    s_cmp_lg_u32 s99, 0
    s_cbranch_scc1 k_noready
    buffer_atomic_add v31, v27, s[32:35], 0 offen sc1
k_noready:
    s_cmp_ge_u32 s37, 14
    s_cbranch_scc1 k_dft
    s_waitcnt lgkmcnt(1)
    v_mfma_f32_16x16x32_bf16 v[32:35], a[96:99], a[64:67], 0
    ds_read_b128 a[72:75], v16 offset:1024
    v_lshlrev_b32_e64 v29, 2, v0
    v_mfma_f32_16x16x32_bf16 v[36:39], a[100:103], a[64:67], 0
    ds_read_b128 a[76:79], v16 offset:9216
    v_lshl_add_u32 v28, v1, 8, v29
    v_mfma_f32_16x16x32_bf16 v[40:43], a[104:107], a[64:67], 0
    s_lshl4_add_u32 s61, s37, s40
    s_lshl_b32 s61, s61, 8
    s_add_u32 s61, s61, 9699328
    v_mfma_f32_16x16x32_bf16 v[44:47], a[108:111], a[64:67], 0
    ds_read_b128 a[80:83], v16 offset:2048
    s_bfe_u32 s4, s2, 131077
    v_mfma_f32_16x16x32_bf16 v[196:199], v[192:195], a[96:99], 0
    ds_read_b128 a[84:87], v16 offset:10240
    s_lshl_b32 s4, s4, 283
    v_mfma_f32_16x16x32_bf16 v[200:203], v[192:195], a[100:103], 0
    ds_read_b128 a[88:91], v16 offset:3072
    s_add_u32 s61, s61, s4
    v_mfma_f32_16x16x32_bf16 v[204:207], v[192:195], a[104:107], 0
    s_mov_b32 s4, 0xffff0000
    s_mov_b32 s5, 0xffff0000
    s_mov_b32 s6, 0
    v_mfma_f32_16x16x32_bf16 v[208:211], v[192:195], a[108:111], 0
    ds_read_b128 a[92:95], v16 offset:11264
    s_waitcnt lgkmcnt(6)
    v_mfma_f32_16x16x32_bf16 v[60:63], a[108:111], a[68:71], 0
    ds_read_b128 a[112:115], v17 offset:0
    s_mov_b32 s7, -1
    v_mfma_f32_16x16x32_bf16 v[56:59], a[104:107], a[68:71], 0
    ds_read_b128 a[116:119], v17 offset:8192
    s_mov_b32 s62, 9666560
    v_mfma_f32_16x16x32_bf16 v[52:55], a[100:103], a[68:71], 0
    s_mul_i32 s47, s37, 37
    s_lshr_b32 s47, s47, 263
    s_lshl3_add_u32 s47, s36, s47
    v_mfma_f32_16x16x32_bf16 v[48:51], a[96:99], a[68:71], 0
    ds_read_b128 a[120:123], v17 offset:1024
    s_waitcnt lgkmcnt(7)
    v_mfma_f32_16x16x32_bf16 v[64:67], a[96:99], a[72:75], 0
    ds_read_b128 a[124:127], v17 offset:9216
    s_lshl2_add_u32 s47, s47, s38
    v_mfma_f32_16x16x32_bf16 v[68:71], a[100:103], a[72:75], 0
    ds_read_b128 a[128:131], v17 offset:2048
    s_lshl_b32 s47, s47, 263
    v_mfma_f32_16x16x32_bf16 v[72:75], a[104:107], a[72:75], 0
    buffer_load_dwordx4 v12, s[8:11], s45 offen offset:2048 lds
    v_mfma_f32_16x16x32_bf16 v[76:79], a[108:111], a[72:75], 0
    ds_read_b128 a[132:135], v17 offset:10240
    s_add_u32 s47, s47, 9601024
    v_mfma_f32_16x16x32_bf16 v[92:95], a[108:111], a[76:79], 0
    ds_read_b128 a[136:139], v17 offset:3072
    s_lshr_b32 s60, 64503, s37
    v_mfma_f32_16x16x32_bf16 v[88:91], a[104:107], a[76:79], 0
    ds_read_b128 a[140:143], v17 offset:11264
    s_and_b32 s60, s60, 1
    v_mfma_f32_16x16x32_bf16 v[84:87], a[100:103], a[76:79], 0
    buffer_load_dwordx4 v13, s[8:11], s45 offen offset:3072 lds
    v_mfma_f32_16x16x32_bf16 v[80:83], a[96:99], a[76:79], 0
    s_add_u32 m0, s43, 32768
    s_waitcnt lgkmcnt(10)
    s_and_b32 s51, s2, 6
    v_mfma_f32_16x16x32_bf16 v[96:99], a[96:99], a[80:83], 0
    s_xor_b32 s44, s40, 2
    s_bfe_u32 s52, s2, 0x10004
    s_add_u32 s51, s51, s52
    v_mfma_f32_16x16x32_bf16 v[100:103], a[100:103], a[80:83], 0
    s_mul_i32 s44, s44, s42
    s_and_b32 s52, s2, 1
    s_lshl1_add_u32 s51, s51, s52
    v_mfma_f32_16x16x32_bf16 v[104:107], a[104:107], a[80:83], 0
    buffer_load_dwordx4 v8, s[12:15], s44 offen offset:0 lds
    v_mfma_f32_16x16x32_bf16 v[108:111], a[108:111], a[80:83], 0
    s_sub_u32 s52, 16, s51
    s_and_b32 s52, s52, 15
    s_add_u32 s52, s52, 16
    v_mfma_f32_16x16x32_bf16 v[124:127], a[108:111], a[84:87], 0
    s_sub_u32 s52, s52, s51
    s_bfe_u32 s49, s2, 65543
    s_mul_i32 s52, s52, s49
    v_mfma_f32_16x16x32_bf16 v[120:123], a[104:107], a[84:87], 0
    s_add_u32 s49, s51, s52
    s_bfe_u32 s51, s2, 0x20005
    s_bfe_u32 s52, s2, 0x10003
    v_mfma_f32_16x16x32_bf16 v[116:119], a[100:103], a[84:87], 0
    buffer_load_dwordx4 v8, s[16:19], s44 offen offset:1024 lds
    v_mfma_f32_16x16x32_bf16 v[112:115], a[96:99], a[84:87], 0
    s_waitcnt lgkmcnt(8)
    s_lshl1_add_u32 s50, s51, s52
    s_xor_b32 s50, s50, 1
    v_mfma_f32_16x16x32_bf16 v[128:131], a[96:99], a[88:91], 0
    s_and_b32 s51, s50, 7
    s_mul_i32 s51, s51, 0
    s_lshr_b32 s51, s51, 2
    v_mfma_f32_16x16x32_bf16 v[132:135], a[100:103], a[88:91], 0
    s_lshl_b32 s51, s51, 10
    s_bfe_u32 s52, s2, 0x10004
    s_lshr_b32 s64, s2, 7
    v_mfma_f32_16x16x32_bf16 v[136:139], a[104:107], a[88:91], 0
    buffer_load_dwordx4 v9, s[12:15], s44 offen offset:2048 lds
    v_mfma_f32_16x16x32_bf16 v[140:143], a[108:111], a[88:91], 0
    s_lshl1_add_u32 s52, s52, s64
    s_and_b32 s52, s52, 2
    s_mul_i32 s52, s52, 7
    v_mfma_f32_16x16x32_bf16 v[156:159], a[108:111], a[92:95], 0
    s_lshr_b32 s52, s52, 1
    s_lshl_b32 s52, s52, 10
    s_add_u32 s51, s51, s52
    v_mfma_f32_16x16x32_bf16 v[152:155], a[104:107], a[92:95], 0
    s_sub_u32 s52, s51, 14336
    s_min_u32 s64, s51, s52
    s_mov_b32 s30, 2097152
    v_mfma_f32_16x16x32_bf16 v[148:151], a[100:103], a[92:95], 0
    buffer_load_dwordx4 v9, s[16:19], s44 offen offset:3072 lds
    v_mfma_f32_16x16x32_bf16 v[144:147], a[96:99], a[92:95], 0
    s_waitcnt vmcnt(10) lgkmcnt(8)
    s_barrier
    ds_read_b64_tr_b16 a[144:145], v14 offset:16384
    ds_read_b64_tr_b16 a[146:147], v14 offset:20480
    ds_read_b64_tr_b16 a[148:149], v15 offset:16384
    ds_read_b64_tr_b16 a[150:151], v15 offset:20480
    ds_read_b64_tr_b16 a[152:153], v14 offset:17408
    ds_read_b64_tr_b16 a[154:155], v14 offset:21504
    ds_read_b64_tr_b16 a[156:157], v15 offset:17408
    ds_read_b64_tr_b16 a[158:159], v15 offset:21504
    s_add_u32 m0, s43, 49152
    s_xor_b32 s44, s40, 3
    s_mul_i32 s44, s44, s42
    buffer_load_dwordx4 v8, s[12:15], s44 offen offset:0 lds
    s_mov_b32 s96, 0xbf803f80
    s_waitcnt vmcnt(9)
    v_dot2_f32_bf16 v168, v160, v192, 0
    v_dot2_f32_bf16 v169, v160, s96, 0
    v_dot2_f32_bf16 v168, v161, v192, v168
    v_dot2_f32_bf16 v169, v161, s96, v169
    v_dot2_f32_bf16 v168, v162, v192, v168
    v_dot2_f32_bf16 v169, v162, s96, v169
    v_dot2_f32_bf16 v168, v163, v192, v168
    v_dot2_f32_bf16 v169, v163, s96, v169
    buffer_load_dwordx4 v8, s[16:19], s44 offen offset:1024 lds
    v_dot2_f32_bf16 v168, v164, v192, v168
    v_dot2_f32_bf16 v169, v164, s96, v169
    v_dot2_f32_bf16 v168, v165, v192, v168
    v_dot2_f32_bf16 v169, v165, s96, v169
    v_dot2_f32_bf16 v168, v166, v192, v168
    v_dot2_f32_bf16 v169, v166, s96, v169
    v_dot2_f32_bf16 v168, v167, v192, v168
    v_dot2_f32_bf16 v169, v167, s96, v169
    buffer_load_dwordx4 v9, s[12:15], s44 offen offset:2048 lds
    s_waitcnt lgkmcnt(0)
    v_mfma_f32_16x16x32_bf16 v[32:35], a[144:147], a[112:115], v[32:35]
    s_movk_i32 s97, 0x3f80
    s_mov_b32 s98, 1.0
    s_mov_b32 s31, s11
    v_mfma_f32_16x16x32_bf16 v[36:39], a[148:151], a[112:115], v[36:39]
    s_mul_i32 s52, s38, 458752
    v_add_f32_dpp v168, v168, v168 quad_perm:[1,0,3,2] row_mask:0xf bank_mask:0xf
    v_add_f32_dpp v169, v169, v169 quad_perm:[1,0,3,2] row_mask:0xf bank_mask:0xf
    v_mfma_f32_16x16x32_bf16 v[40:43], a[152:155], a[112:115], v[40:43]
    s_lshl_b32 s51, s50, 263
    v_add_f32_dpp v168, v168, v168 quad_perm:[2,3,0,1] row_mask:0xf bank_mask:0xf
    v_add_f32_dpp v169, v169, v169 quad_perm:[2,3,0,1] row_mask:0xf bank_mask:0xf
    v_mfma_f32_16x16x32_bf16 v[44:47], a[156:159], a[112:115], v[44:47]
    s_add_u32 s51, s51, s52
    v_add_f32_dpp v168, v168, v168 row_half_mirror row_mask:0xf bank_mask:0xf
    v_add_f32_dpp v169, v169, v169 row_half_mirror row_mask:0xf bank_mask:0xf
    v_mfma_f32_16x16x32_bf16 v[196:199], v[192:195], a[144:147], v[196:199]
    v_add_f32_dpp v168, v168, v168 row_mirror row_mask:0xf bank_mask:0xf
    v_add_f32_dpp v169, v169, v169 row_mirror row_mask:0xf bank_mask:0xf
    v_mfma_f32_16x16x32_bf16 v[200:203], v[192:195], a[148:151], v[200:203]
    v_mov_b32 v172, v168
    v_mov_b32 v173, v169
    v_mfma_f32_16x16x32_bf16 v[204:207], v[192:195], a[152:155], v[204:207]
    v_permlane16_swap_b32 v168, v172
    v_mfma_f32_16x16x32_bf16 v[208:211], v[192:195], a[156:159], v[208:211]
    v_permlane16_swap_b32 v169, v173
    v_mfma_f32_16x16x32_bf16 v[60:63], a[156:159], a[116:119], v[60:63]
    v_add_f32 v168, v168, v172
    v_add_f32_e64 v169, v169, v173
    v_mfma_f32_16x16x32_bf16 v[56:59], a[152:155], a[116:119], v[56:59]
    v_mul_f32 v168, 0xbb000000, v168
    v_lshrrev_b32_e64 v2, 3, v0
    v_mfma_f32_16x16x32_bf16 v[52:55], a[148:151], a[116:119], v[52:55]
    buffer_load_dwordx4 v9, s[16:19], s44 offen offset:3072 lds
    v_mfma_f32_16x16x32_bf16 v[48:51], a[144:147], a[116:119], v[48:51]
    v_lshrrev_b32 v3, 4, v0
    v_lshlrev_b32 v3, 1, v3
    v_mfma_f32_16x16x32_bf16 v[64:67], a[144:147], a[120:123], v[64:67]
    s_add_u32 m0, s43, 98304
    v_and_b32 v4, 7, v0
    v_xor_b32 v3, v3, v4
    v_mfma_f32_16x16x32_bf16 v[68:71], a[148:151], a[120:123], v[68:71]
    s_xor_b32 s45, s41, 256
    v_lshl_add_u32 v3, v3, 4, s51
    v_lshl_add_u32 v18, v2, 10, v3
    v_mfma_f32_16x16x32_bf16 v[72:75], a[152:155], a[120:123], v[72:75]
    buffer_load_dwordx4 v10, s[8:11], s45 offen offset:0 lds
    v_mfma_f32_16x16x32_bf16 v[76:79], a[156:159], a[120:123], v[76:79]
    v_add_u32 v19, 7168, v18
    v_add_u32 v20, 14336, v18
    v_mfma_f32_16x16x32_bf16 v[92:95], a[156:159], a[124:127], v[92:95]
    v_add_u32 v21, 21504, v18
    v_bfe_u32 v2, v0, 2, 3
    v_mfma_f32_16x16x32_bf16 v[88:91], a[152:155], a[124:127], v[88:91]
    v_lshrrev_b32 v3, 5, v0
    v_lshlrev_b32 v3, 10, v3
    v_mfma_f32_16x16x32_bf16 v[84:87], a[148:151], a[124:127], v[84:87]
    buffer_load_dwordx4 v11, s[8:11], s45 offen offset:1024 lds
    v_mfma_f32_16x16x32_bf16 v[80:83], a[144:147], a[124:127], v[80:83]
    v_lshl_add_u32 v3, v2, 7, v3
    v_lshl_add_u32 v3, v1, 12, v3
    v_mfma_f32_16x16x32_bf16 v[96:99], a[144:147], a[128:131], v[96:99]
    v_and_b32_e64 v4, 3, v0
    v_lshl_add_u32 v3, v4, 3, v3
    v_mfma_f32_16x16x32_bf16 v[100:103], a[148:151], a[128:131], v[100:103]
    v_lshrrev_b32 v2, 1, v2
    v_and_b32 v4, 2, v1
    v_mfma_f32_16x16x32_bf16 v[104:107], a[152:155], a[128:131], v[104:107]
    buffer_load_dwordx4 v12, s[8:11], s45 offen offset:2048 lds
    v_mfma_f32_16x16x32_bf16 v[108:111], a[156:159], a[128:131], v[108:111]
    v_xor_b32_e64 v2, v2, v4
    v_lshl_add_u32 v3, v2, 5, v3
    v_mfma_f32_16x16x32_bf16 v[124:127], a[156:159], a[132:135], v[124:127]
    v_add_u32 v22, 98304, v3
    v_xor_b32 v23, 32, v22
    v_mfma_f32_16x16x32_bf16 v[120:123], a[152:155], a[132:135], v[120:123]
    v_xor_b32 v24, 64, v22
    v_xor_b32 v25, 96, v22
    v_mfma_f32_16x16x32_bf16 v[116:119], a[148:151], a[132:135], v[116:119]
    buffer_load_dwordx4 v13, s[8:11], s45 offen offset:3072 lds
    v_mfma_f32_16x16x32_bf16 v[112:115], a[144:147], a[132:135], v[112:115]
    s_add_u32 m0, s43, 0
    s_add_u32 s65, s64, 1024
    s_sub_u32 s3, s64, 13312
    v_mfma_f32_16x16x32_bf16 v[128:131], a[144:147], a[136:139], v[128:131]
    s_xor_b32 s44, s40, 4
    s_min_u32 s65, s65, s3
    v_mfma_f32_16x16x32_bf16 v[132:135], a[148:151], a[136:139], v[132:135]
    s_mul_i32 s44, s44, s42
    s_add_u32 s66, s64, 2048
    s_sub_u32 s3, s64, 12288
    v_mfma_f32_16x16x32_bf16 v[136:139], a[152:155], a[136:139], v[136:139]
    buffer_load_dwordx4 v8, s[12:15], s44 offen offset:0 lds
    v_mfma_f32_16x16x32_bf16 v[140:143], a[156:159], a[136:139], v[140:143]
    s_min_u32 s66, s66, s3
    v_mfma_f32_16x16x32_bf16 v[156:159], a[156:159], a[140:143], v[156:159]
    s_add_u32 s67, s64, 3072
    s_sub_u32 s3, s64, 11264
    s_min_u32 s67, s67, s3
    v_mfma_f32_16x16x32_bf16 v[152:155], a[152:155], a[140:143], v[152:155]
    s_add_u32 s68, s64, 4096
    s_sub_u32 s3, s64, 10240
    s_min_u32 s68, s68, s3
    s_nop 0
k_pad4:
    s_cbranch_execz k_padback
    s_nop 0
    v_mfma_f32_16x16x32_bf16 v[148:151], a[148:151], a[140:143], v[148:151]
    buffer_load_dwordx4 v8, s[16:19], s44 offen offset:1024 lds
    v_mfma_f32_16x16x32_bf16 v[144:147], a[144:147], a[140:143], v[144:147]
    v_dot2_f32_bf16 v176, v160, s97, v168
    v_dot2_f32_bf16 v160, v160, s98, v168
    v_dot2_f32_bf16 v177, v161, s97, v168
    v_dot2_f32_bf16 v161, v161, s98, v168
    v_dot2_f32_bf16 v178, v162, s97, v168
    v_dot2_f32_bf16 v162, v162, s98, v168
    v_dot2_f32_bf16 v179, v163, s97, v168
    v_dot2_f32_bf16 v163, v163, s98, v168
    v_dot2_f32_bf16 v180, v164, s97, v168
    v_dot2_f32_bf16 v164, v164, s98, v168
    v_dot2_f32_bf16 v181, v165, s97, v168
    v_dot2_f32_bf16 v165, v165, s98, v168
    buffer_load_dwordx4 v9, s[12:15], s44 offen offset:2048 lds
    v_dot2_f32_bf16 v182, v166, s97, v168
    v_dot2_f32_bf16 v166, v166, s98, v168
    v_dot2_f32_bf16 v183, v167, s97, v168
    v_dot2_f32_bf16 v167, v167, s98, v168
    v_pk_mul_f32 v[170:171], v[176:177], v[176:177]
    v_pk_fma_f32 v[170:171], v[160:161], v[160:161], v[170:171]
    v_pk_fma_f32 v[170:171], v[178:179], v[178:179], v[170:171]
    v_pk_fma_f32 v[170:171], v[162:163], v[162:163], v[170:171]
    v_pk_fma_f32 v[170:171], v[180:181], v[180:181], v[170:171]
    v_pk_fma_f32 v[170:171], v[164:165], v[164:165], v[170:171]
    v_pk_fma_f32 v[170:171], v[182:183], v[182:183], v[170:171]
    v_pk_fma_f32 v[170:171], v[166:167], v[166:167], v[170:171]
    v_add_f32_e64 v170, v170, v171
    s_waitcnt vmcnt(11) lgkmcnt(0)
    s_barrier
    ds_read_b64_tr_b16 a[96:97], v14 offset:32768
    ds_read_b64_tr_b16 a[98:99], v14 offset:36864
    ds_read_b64_tr_b16 a[100:101], v15 offset:32768
    ds_read_b64_tr_b16 a[102:103], v15 offset:36864
    ds_read_b64_tr_b16 a[104:105], v14 offset:33792
    ds_read_b64_tr_b16 a[106:107], v14 offset:37888
    ds_read_b64_tr_b16 a[108:109], v15 offset:33792
    ds_read_b64_tr_b16 a[110:111], v15 offset:37888
    ds_read_b128 a[64:67], v16 offset:16384
    ds_read_b128 a[68:71], v16 offset:24576
    buffer_load_dwordx4 v9, s[16:19], s44 offen offset:3072 lds
    s_waitcnt lgkmcnt(1)
    v_mfma_f32_16x16x32_bf16 v[32:35], a[96:99], a[64:67], v[32:35]
    s_add_u32 m0, s43, 16384
    s_xor_b32 s44, s40, 5
    v_add_f32_dpp v170, v170, v170 quad_perm:[1,0,3,2] row_mask:0xf bank_mask:0xf
    v_mfma_f32_16x16x32_bf16 v[36:39], a[100:103], a[64:67], v[36:39]
    ds_read_b128 a[72:75], v16 offset:17408
    s_mul_i32 s44, s44, s42
    v_mfma_f32_16x16x32_bf16 v[40:43], a[104:107], a[64:67], v[40:43]
    buffer_load_dwordx4 v8, s[12:15], s44 offen offset:0 lds
    v_mfma_f32_16x16x32_bf16 v[44:47], a[108:111], a[64:67], v[44:47]
    ds_read_b128 a[76:79], v16 offset:25600
    v_add_f32_dpp v170, v170, v170 quad_perm:[2,3,0,1] row_mask:0xf bank_mask:0xf
    v_mfma_f32_16x16x32_bf16 v[196:199], v[192:195], a[96:99], v[196:199]
    ds_read_b128 a[80:83], v16 offset:18432
    s_lshr_b32 s51, s2, 4
    v_mfma_f32_16x16x32_bf16 v[200:203], v[192:195], a[100:103], v[200:203]
    ds_read_b128 a[84:87], v16 offset:26624
    v_add_f32_dpp v170, v170, v170 row_half_mirror row_mask:0xf bank_mask:0xf
    v_mfma_f32_16x16x32_bf16 v[204:207], v[192:195], a[104:107], v[204:207]
    buffer_load_dwordx4 v8, s[16:19], s44 offen offset:1024 lds
    v_mfma_f32_16x16x32_bf16 v[208:211], v[192:195], a[108:111], v[208:211]
    ds_read_b128 a[88:91], v16 offset:19456
    s_waitcnt lgkmcnt(5)
    v_mfma_f32_16x16x32_bf16 v[60:63], a[108:111], a[68:71], v[60:63]
    ds_read_b128 a[92:95], v16 offset:27648
    v_add_f32_dpp v170, v170, v170 row_mirror row_mask:0xf bank_mask:0xf
    v_mfma_f32_16x16x32_bf16 v[56:59], a[104:107], a[68:71], v[56:59]
    ds_read_b128 a[112:115], v17 offset:16384
    s_and_b32 s52, s2, 7
    v_mfma_f32_16x16x32_bf16 v[52:55], a[100:103], a[68:71], v[52:55]
    buffer_load_dwordx4 v9, s[12:15], s44 offen offset:2048 lds
    v_mfma_f32_16x16x32_bf16 v[48:51], a[96:99], a[68:71], v[48:51]
    s_waitcnt lgkmcnt(5)
    s_waitcnt vmcnt(11) lgkmcnt(1)
    s_barrier
    s_nop 0
    s_load_dword s96, s[32:33], 0
    v_mfma_f32_16x16x32_bf16 v[64:67], a[96:99], a[72:75], v[64:67]
    ds_read_b128 a[116:119], v17 offset:24576
    ds_read_b64_tr_b16 a[144:145], v14 offset:49152
    v_mfma_f32_16x16x32_bf16 v[68:71], a[100:103], a[72:75], v[68:71]
    ds_read_b128 a[120:123], v17 offset:17408
    ds_read_b64_tr_b16 a[146:147], v14 offset:53248
    v_mfma_f32_16x16x32_bf16 v[72:75], a[104:107], a[72:75], v[72:75]
    buffer_load_dwordx4 v9, s[16:19], s44 offen offset:3072 lds
    v_mfma_f32_16x16x32_bf16 v[76:79], a[108:111], a[72:75], v[76:79]
    ds_read_b128 a[124:127], v17 offset:25600
    ds_read_b64_tr_b16 a[148:149], v15 offset:49152
    v_mfma_f32_16x16x32_bf16 v[92:95], a[108:111], a[76:79], v[92:95]
    ds_read_b128 a[128:131], v17 offset:18432
    s_add_u32 m0, s43, 65536
    v_mfma_f32_16x16x32_bf16 v[88:91], a[104:107], a[76:79], v[88:91]
    ds_read_b128 a[132:135], v17 offset:26624
    s_xor_b32 s45, s41, 384
    v_mfma_f32_16x16x32_bf16 v[84:87], a[100:103], a[76:79], v[84:87]
    buffer_load_dwordx4 v10, s[8:11], s45 offen offset:0 lds
    v_mfma_f32_16x16x32_bf16 v[80:83], a[96:99], a[76:79], v[80:83]
    ds_read_b128 a[136:139], v17 offset:19456
    s_waitcnt lgkmcnt(12)
    v_mfma_f32_16x16x32_bf16 v[96:99], a[96:99], a[80:83], v[96:99]
    ds_read_b128 a[140:143], v17 offset:27648
    ds_read_b64_tr_b16 a[150:151], v15 offset:53248
    v_mfma_f32_16x16x32_bf16 v[100:103], a[100:103], a[80:83], v[100:103]
    ds_read_b64_tr_b16 a[152:153], v14 offset:50176
    v_mov_b32 v172, v170
    v_mfma_f32_16x16x32_bf16 v[104:107], a[104:107], a[80:83], v[104:107]
    buffer_load_dwordx4 v11, s[8:11], s45 offen offset:1024 lds
    v_mfma_f32_16x16x32_bf16 v[108:111], a[108:111], a[80:83], v[108:111]
    ds_read_b64_tr_b16 a[154:155], v14 offset:54272
    v_permlane16_swap_b32_e64 v170, v172
    v_mfma_f32_16x16x32_bf16 v[124:127], a[108:111], a[84:87], v[124:127]
    ds_read_b64_tr_b16 a[156:157], v15 offset:50176
    s_lshl3_add_u32 s51, s51, s52
    v_mfma_f32_16x16x32_bf16 v[120:123], a[104:107], a[84:87], v[120:123]
    ds_read_b64_tr_b16 a[158:159], v15 offset:54272
    v_add_f32 v170, v170, v172
    v_mfma_f32_16x16x32_bf16 v[116:119], a[100:103], a[84:87], v[116:119]
    buffer_load_dwordx4 v12, s[8:11], s45 offen offset:2048 lds
    v_mfma_f32_16x16x32_bf16 v[112:115], a[96:99], a[84:87], v[112:115]
    s_waitcnt lgkmcnt(15)
    v_mul_f32 v170, 0x3b000000, v170
    v_cvt_pk_bf16_f32 v170, 0, v170
    v_mfma_f32_16x16x32_bf16 v[128:131], a[96:99], a[88:91], v[128:131]
    s_lshl2_add_u32 s51, s51, s38
    v_add_f32 v170, 0x3727c5ac, v170
    v_cvt_pk_bf16_f32 v170, 0, v170
    v_mfma_f32_16x16x32_bf16 v[132:135], a[100:103], a[88:91], v[132:135]
    s_mul_i32 s51, s51, 3584
    v_sqrt_f32_e64 v170, v170
    v_mfma_f32_16x16x32_bf16 v[136:139], a[104:107], a[88:91], v[136:139]
    buffer_load_dwordx4 v13, s[8:11], s45 offen offset:3072 lds
    v_mfma_f32_16x16x32_bf16 v[140:143], a[108:111], a[88:91], v[140:143]
    s_add_u32 m0, s43, 32768
    v_cvt_pk_bf16_f32 v172, 0, v168
    v_cvt_pk_bf16_f32 v170, 0, v170
    v_mfma_f32_16x16x32_bf16 v[156:159], a[108:111], a[92:95], v[156:159]
    s_xor_b32 s44, s40, 6
    v_rcp_f32 v175, v170
    v_mfma_f32_16x16x32_bf16 v[152:155], a[104:107], a[92:95], v[152:155]
    s_mul_i32 s44, s44, s42
    v_mul_f32 v173, v170, v170
    v_mul_f32 v174, 0xbfb8aa3b, v175
    v_mfma_f32_16x16x32_bf16 v[148:151], a[100:103], a[92:95], v[148:151]
    buffer_load_dwordx4 v8, s[12:15], s44 offen offset:0 lds
    v_mfma_f32_16x16x32_bf16 v[144:147], a[96:99], a[92:95], v[144:147]
    s_waitcnt vmcnt(9) lgkmcnt(0)
    s_barrier
    v_mfma_f32_16x16x32_bf16 v[32:35], a[144:147], a[112:115], v[32:35]
    ds_read_b64_tr_b16 a[96:97], v14 offset:0
    v_mul_f32_e64 v175, v169, v175
    v_mfma_f32_16x16x32_bf16 v[36:39], a[148:151], a[112:115], v[36:39]
    ds_read_b128 a[64:67], v16 offset:32768
    s_cmp_lt_i32 s96, 8
    s_cbranch_scc1 frdy_slow
frdy_back:
    v_mfma_f32_16x16x32_bf16 v[40:43], a[152:155], a[112:115], v[40:43]
    buffer_load_dwordx4 v8, s[16:19], s44 offen offset:1024 lds
    v_mfma_f32_16x16x32_bf16 v[44:47], a[156:159], a[112:115], v[44:47]
    ds_read_b64_tr_b16 a[98:99], v14 offset:4096
    s_and_b32 s52, s2, 8
    v_mfma_f32_16x16x32_bf16 v[196:199], v[192:195], a[144:147], v[196:199]
    ds_read_b128 a[68:71], v16 offset:40960
    s_lshl_b32 s52, s52, 24
    v_mfma_f32_16x16x32_bf16 v[200:203], v[192:195], a[148:151], v[200:203]
    ds_read_b64_tr_b16 a[100:101], v15 offset:0
    s_add_u32 s51, s51, s52
    v_mfma_f32_16x16x32_bf16 v[204:207], v[192:195], a[152:155], v[204:207]
    buffer_load_dwordx4 v9, s[12:15], s44 offen offset:2048 lds
    v_mfma_f32_16x16x32_bf16 v[208:211], v[192:195], a[156:159], v[208:211]
    ds_read_b128 a[72:75], v16 offset:33792
    v_min_u32 v2, 27, v0
    v_mfma_f32_16x16x32_bf16 v[60:63], a[156:159], a[116:119], v[60:63]
    ds_read_b64_tr_b16 a[102:103], v15 offset:4096
    v_lshlrev_b32_e64 v2, 7, v2
    v_mfma_f32_16x16x32_bf16 v[56:59], a[152:155], a[116:119], v[56:59]
    ds_read_b128 a[76:79], v16 offset:41984
    s_add_u32 s69, s64, 5120
    v_mfma_f32_16x16x32_bf16 v[52:55], a[148:151], a[116:119], v[52:55]
    buffer_load_dwordx4 v9, s[16:19], s44 offen offset:3072 lds
    v_mfma_f32_16x16x32_bf16 v[48:51], a[144:147], a[116:119], v[48:51]
    ds_read_b64_tr_b16 a[104:105], v14 offset:1024
    s_add_u32 m0, s43, 49152
    v_mfma_f32_16x16x32_bf16 v[64:67], a[144:147], a[120:123], v[64:67]
    ds_read_b128 a[80:83], v16 offset:34816
    s_xor_b32 s44, s40, 7
    v_mfma_f32_16x16x32_bf16 v[68:71], a[148:151], a[120:123], v[68:71]
    ds_read_b64_tr_b16 a[106:107], v14 offset:5120
    s_mul_i32 s44, s44, s42
    v_mfma_f32_16x16x32_bf16 v[72:75], a[152:155], a[120:123], v[72:75]
    buffer_load_dwordx4 v8, s[12:15], s44 offen offset:0 lds
    v_mfma_f32_16x16x32_bf16 v[76:79], a[156:159], a[120:123], v[76:79]
    ds_read_b128 a[84:87], v16 offset:43008
    v_cndmask_b32 v196, v196, v200, s[4:5]
    v_mfma_f32_16x16x32_bf16 v[92:95], a[156:159], a[124:127], v[92:95]
    ds_read_b64_tr_b16 a[108:109], v15 offset:1024
    v_cndmask_b32 v204, v204, v208, s[4:5]
    v_mfma_f32_16x16x32_bf16 v[88:91], a[152:155], a[124:127], v[88:91]
    ds_read_b128 a[88:91], v16 offset:35840
    v_cndmask_b32 v196, v196, v204, s[6:7]
    v_mfma_f32_16x16x32_bf16 v[84:87], a[148:151], a[124:127], v[84:87]
    buffer_load_dwordx4 v8, s[16:19], s44 offen offset:1024 lds
    v_mfma_f32_16x16x32_bf16 v[80:83], a[144:147], a[124:127], v[80:83]
    ds_read_b64_tr_b16 a[110:111], v15 offset:5120
    s_sub_u32 s3, s64, 9216
    v_mfma_f32_16x16x32_bf16 v[96:99], a[144:147], a[128:131], v[96:99]
    ds_read_b128 a[92:95], v16 offset:44032
    s_min_u32 s69, s69, s3
    v_mfma_f32_16x16x32_bf16 v[100:103], a[148:151], a[128:131], v[100:103]
    buffer_store_dwordx4 v[172:175], v5, s[20:23], s62 offen sc1
    v_mfma_f32_16x16x32_bf16 v[104:107], a[152:155], a[128:131], v[104:107]
    buffer_load_dwordx4 v9, s[12:15], s44 offen offset:2048 lds
    v_mfma_f32_16x16x32_bf16 v[108:111], a[156:159], a[128:131], v[108:111]
    buffer_store_dword v196, v28, s[20:23], s61 offen sc1
    v_mfma_f32_16x16x32_bf16 v[124:127], a[156:159], a[132:135], v[124:127]
    buffer_load_dword v254, v2, s[24:27], s51 offen
    v_mfma_f32_16x16x32_bf16 v[120:123], a[152:155], a[132:135], v[120:123]
    s_add_u32 s52, s37, 4
    s_lshr_b32 s52, s52, 4
    s_lshr_b32 s51, s2, 5
    v_mfma_f32_16x16x32_bf16 v[116:119], a[148:151], a[132:135], v[116:119]
    buffer_load_dwordx4 v9, s[16:19], s44 offen offset:3072 lds
    v_mfma_f32_16x16x32_bf16 v[112:115], a[144:147], a[132:135], v[112:115]
    s_lshl_b32 s51, s51, 258
    s_lshr_b32 s51, s51, s52
    s_and_b32 s55, s37, 3
    v_mfma_f32_16x16x32_bf16 v[128:131], a[144:147], a[136:139], v[128:131]
    s_add_u32 m0, s43, 81920
    s_add_u32 s51, s51, s55
    s_lshl2_add_u32 s51, s51, s38
    v_mfma_f32_16x16x32_bf16 v[132:135], a[148:151], a[136:139], v[132:135]
    s_xor_b32 s45, s41, 512
    s_lshl_b32 s52, 14, s52
    s_mul_i32 s51, s51, s52
    v_mfma_f32_16x16x32_bf16 v[136:139], a[152:155], a[136:139], v[136:139]
    buffer_load_dwordx4 v10, s[8:11], s45 offen offset:0 lds
    v_mfma_f32_16x16x32_bf16 v[140:143], a[156:159], a[136:139], v[140:143]
    s_lshl_b32 s51, s51, 10
    s_sub_u32 s52, s52, 1
    v_min_u32 v2, s52, v0
    v_mfma_f32_16x16x32_bf16 v[156:159], a[156:159], a[140:143], v[156:159]
    s_lshl_b32 s61, s37, 12
    s_add_u32 s61, s61, 9699328
    v_lshlrev_b32_e64 v2, 10, v2
    v_mfma_f32_16x16x32_bf16 v[152:155], a[152:155], a[140:143], v[152:155]
    buffer_load_dword v254, v2, s[24:27], s51 offen offset:384
    v_mfma_f32_16x16x32_bf16 v[148:151], a[148:151], a[140:143], v[148:151]
    buffer_load_dwordx4 v11, s[8:11], s45 offen offset:1024 lds
    v_mfma_f32_16x16x32_bf16 v[144:147], a[144:147], a[140:143], v[144:147]
    s_waitcnt vmcnt(18) lgkmcnt(0)
    s_barrier
    v_mfma_f32_16x16x32_bf16 v[32:35], a[96:99], a[64:67], v[32:35]
    ds_read_b64_tr_b16 a[144:145], v14 offset:16384
    s_lshl_b32 s62, s36, 267
    v_mfma_f32_16x16x32_bf16 v[36:39], a[100:103], a[64:67], v[36:39]
    ds_read_b128 a[112:115], v17 offset:32768
    s_add_u32 s62, s62, 9666560
    v_mfma_f32_16x16x32_bf16 v[40:43], a[104:107], a[64:67], v[40:43]
    s_add_u32 s4, s43, 147456
    v_and_b32 v6, 3, v0
    v_and_b32 v28, 48, v0
    v_mfma_f32_16x16x32_bf16 v[44:47], a[108:111], a[64:67], v[44:47]
    ds_read_b64_tr_b16 a[146:147], v14 offset:20480
    v_lshl_add_u32 v28, v6, 10, v28
    v_mfma_f32_16x16x32_bf16 v[60:63], a[108:111], a[68:71], v[60:63]
    ds_read_b128 a[116:119], v17 offset:40960
    v_bfe_u32 v6, v0, 2, 2
    v_mfma_f32_16x16x32_bf16 v[56:59], a[104:107], a[68:71], v[56:59]
    ds_read_b64_tr_b16 a[148:149], v15 offset:16384
    v_lshl_add_u32 v28, v6, 6, v28
    v_mfma_f32_16x16x32_bf16 v[52:55], a[100:103], a[68:71], v[52:55]
    buffer_load_dwordx4 v12, s[8:11], s45 offen offset:2048 lds
    v_mfma_f32_16x16x32_bf16 v[48:51], a[96:99], a[68:71], v[48:51]
    ds_read_b128 a[120:123], v17 offset:33792
    v_lshl_add_u32 v28, v1, 8, v28
    v_mfma_f32_16x16x32_bf16 v[64:67], a[96:99], a[72:75], v[64:67]
    ds_read_b64_tr_b16 a[150:151], v15 offset:20480
    v_add_u32_e64 v7, s4, v26
    v_mfma_f32_16x16x32_bf16 v[68:71], a[100:103], a[72:75], v[68:71]
    ds_read_b128 a[124:127], v17 offset:41984
    v_and_b32 v6, 240, v26
    v_mfma_f32_16x16x32_bf16 v[72:75], a[104:107], a[72:75], v[72:75]
    buffer_load_dwordx4 v13, s[8:11], s45 offen offset:3072 lds
    v_mfma_f32_16x16x32_bf16 v[76:79], a[108:111], a[72:75], v[76:79]
    ds_read_b64_tr_b16 a[152:153], v14 offset:17408
    s_add_u32 m0, s43, 0
    v_mfma_f32_16x16x32_bf16 v[92:95], a[108:111], a[76:79], v[92:95]
    ds_read_b128 a[128:131], v17 offset:34816
    s_xor_b32 s44, s40, 8
    v_mfma_f32_16x16x32_bf16 v[88:91], a[104:107], a[76:79], v[88:91]
    ds_read_b64_tr_b16 a[154:155], v14 offset:21504
    s_mul_i32 s44, s44, s42
    v_mfma_f32_16x16x32_bf16 v[84:87], a[100:103], a[76:79], v[84:87]
    buffer_load_dwordx4 v8, s[12:15], s44 offen offset:0 lds
    v_mfma_f32_16x16x32_bf16 v[80:83], a[96:99], a[76:79], v[80:83]
    ds_read_b128 a[132:135], v17 offset:43008
    v_add_u32 v6, s4, v6
    v_mfma_f32_16x16x32_bf16 v[96:99], a[96:99], a[80:83], v[96:99]
    ds_read_b64_tr_b16 a[156:157], v15 offset:17408
    s_add_u32 s70, s64, 6144
    v_mfma_f32_16x16x32_bf16 v[100:103], a[100:103], a[80:83], v[100:103]
    ds_read_b128 a[136:139], v17 offset:35840
    s_sub_u32 s3, s64, 8192
    v_mfma_f32_16x16x32_bf16 v[104:107], a[104:107], a[80:83], v[104:107]
    buffer_load_dwordx4 v8, s[16:19], s44 offen offset:1024 lds
    v_mfma_f32_16x16x32_bf16 v[108:111], a[108:111], a[80:83], v[108:111]
    ds_read_b64_tr_b16 a[158:159], v15 offset:21504
    s_min_u32 s70, s70, s3
    v_mfma_f32_16x16x32_bf16 v[124:127], a[108:111], a[84:87], v[124:127]
    ds_read_b128 a[140:143], v17 offset:44032
    s_add_u32 s71, s64, 7168
    v_mfma_f32_16x16x32_bf16 v[120:123], a[104:107], a[84:87], v[120:123]
    s_sub_u32 s3, s64, 7168
    s_min_u32 s71, s71, s3
    v_mfma_f32_16x16x32_bf16 v[116:119], a[100:103], a[84:87], v[116:119]
    buffer_load_dwordx4 v9, s[12:15], s44 offen offset:2048 lds
    v_mfma_f32_16x16x32_bf16 v[112:115], a[96:99], a[84:87], v[112:115]
    s_add_u32 s72, s64, 8192
    s_sub_u32 s3, s64, 6144
    s_min_u32 s72, s72, s3
    v_mfma_f32_16x16x32_bf16 v[128:131], a[96:99], a[88:91], v[128:131]
    s_add_u32 s73, s64, 9216
    s_sub_u32 s3, s64, 5120
    s_min_u32 s73, s73, s3
    v_mfma_f32_16x16x32_bf16 v[132:135], a[100:103], a[88:91], v[132:135]
    s_add_u32 s74, s64, 10240
    s_sub_u32 s3, s64, 4096
    s_min_u32 s74, s74, s3
    v_mfma_f32_16x16x32_bf16 v[136:139], a[104:107], a[88:91], v[136:139]
    buffer_load_dwordx4 v9, s[16:19], s44 offen offset:3072 lds
    v_mfma_f32_16x16x32_bf16 v[140:143], a[108:111], a[88:91], v[140:143]
    s_add_u32 s75, s64, 11264
    s_sub_u32 s3, s64, 3072
    s_min_u32 s75, s75, s3
    v_mfma_f32_16x16x32_bf16 v[156:159], a[108:111], a[92:95], v[156:159]
    s_add_u32 m0, s43, 114688
    s_add_u32 s76, s64, 12288
    s_sub_u32 s3, s64, 2048
    v_mfma_f32_16x16x32_bf16 v[152:155], a[104:107], a[92:95], v[152:155]
    s_lshl_b32 s46, s64, 5
    s_min_u32 s76, s76, s3
    v_mfma_f32_16x16x32_bf16 v[148:151], a[100:103], a[92:95], v[148:151]
    buffer_load_dwordx4 v18, s[24:27], s46 offen offset:0 lds
    v_mfma_f32_16x16x32_bf16 v[144:147], a[96:99], a[92:95], v[144:147]
    s_waitcnt vmcnt(17) lgkmcnt(0)
    s_barrier
    v_mfma_f32_16x16x32_bf16 v[32:35], a[144:147], a[112:115], v[32:35]
    ds_read_b64_tr_b16 a[96:97], v14 offset:32768
    s_add_u32 s77, s64, 13312
    v_mfma_f32_16x16x32_bf16 v[36:39], a[148:151], a[112:115], v[36:39]
    ds_read_b128 a[64:67], v16 offset:0
    s_sub_u32 s3, s64, 1024
    v_mfma_f32_16x16x32_bf16 v[40:43], a[152:155], a[112:115], v[40:43]
    s_min_u32 s77, s77, s3
    s_sub_u32 s51, 32, s49
    s_min_u32 s51, s51, s49
    v_mfma_f32_16x16x32_bf16 v[44:47], a[156:159], a[112:115], v[44:47]
    ds_read_b64_tr_b16 a[98:99], v14 offset:36864
    s_add_u32 m0, s43, 16384
    v_mfma_f32_16x16x32_bf16 v[60:63], a[156:159], a[116:119], v[60:63]
    ds_read_b128 a[68:71], v16 offset:8192
    s_xor_b32 s44, s40, 9
    v_mfma_f32_16x16x32_bf16 v[56:59], a[152:155], a[116:119], v[56:59]
    ds_read_b64_tr_b16 a[100:101], v15 offset:32768
    s_mul_i32 s44, s44, s42
    v_mfma_f32_16x16x32_bf16 v[52:55], a[148:151], a[116:119], v[52:55]
    buffer_load_dwordx4 v8, s[12:15], s44 offen offset:0 lds
    v_mfma_f32_16x16x32_bf16 v[48:51], a[144:147], a[116:119], v[48:51]
    ds_read_b128 a[72:75], v16 offset:1024
    s_and_b32 s51, s51, 15
    v_mfma_f32_16x16x32_bf16 v[64:67], a[144:147], a[120:123], v[64:67]
    ds_read_b64_tr_b16 a[102:103], v15 offset:36864
    s_lshl3_add_u32 s52, s51, s38
    v_mfma_f32_16x16x32_bf16 v[68:71], a[148:151], a[120:123], v[68:71]
    ds_read_b128 a[76:79], v16 offset:9216
    s_and_b32 s53, s50, 3
    v_mfma_f32_16x16x32_bf16 v[72:75], a[152:155], a[120:123], v[72:75]
    buffer_load_dwordx4 v8, s[16:19], s44 offen offset:1024 lds
    v_mfma_f32_16x16x32_bf16 v[76:79], a[156:159], a[120:123], v[76:79]
    ds_read_b64_tr_b16 a[104:105], v14 offset:33792
    s_lshl2_add_u32 s52, s52, s53
    v_mfma_f32_16x16x32_bf16 v[92:95], a[156:159], a[124:127], v[92:95]
    ds_read_b128 a[80:83], v16 offset:2048
    s_lshl_b32 s52, s52, 7
    v_mfma_f32_16x16x32_bf16 v[88:91], a[152:155], a[124:127], v[88:91]
    ds_read_b64_tr_b16 a[106:107], v14 offset:37888
    s_add_u32 s58, s52, 9601024
    v_mfma_f32_16x16x32_bf16 v[84:87], a[148:151], a[124:127], v[84:87]
    buffer_load_dwordx4 v9, s[12:15], s44 offen offset:2048 lds
    v_mfma_f32_16x16x32_bf16 v[80:83], a[144:147], a[124:127], v[80:83]
    ds_read_b128 a[84:87], v16 offset:10240
    s_add_u32 s59, s52, 9603072
    v_mfma_f32_16x16x32_bf16 v[96:99], a[144:147], a[128:131], v[96:99]
    ds_read_b64_tr_b16 a[108:109], v15 offset:33792
    s_mul_i32 s55, s38, 14336
    v_mfma_f32_16x16x32_bf16 v[100:103], a[148:151], a[128:131], v[100:103]
    ds_read_b128 a[88:91], v16 offset:3072
    s_mul_i32 s52, s51, 4096
    v_mfma_f32_16x16x32_bf16 v[104:107], a[152:155], a[128:131], v[104:107]
    buffer_load_dwordx4 v9, s[16:19], s44 offen offset:3072 lds
    v_mfma_f32_16x16x32_bf16 v[108:111], a[156:159], a[128:131], v[108:111]
    ds_read_b64_tr_b16 a[110:111], v15 offset:37888
    s_add_u32 s55, s55, s52
    v_mfma_f32_16x16x32_bf16 v[124:127], a[156:159], a[132:135], v[124:127]
    ds_read_b128 a[92:95], v16 offset:11264
    s_add_u32 m0, s43, 98304
    v_mfma_f32_16x16x32_bf16 v[120:123], a[152:155], a[132:135], v[120:123]
    s_xor_b32 s45, s41, 640
    s_lshr_b32 s52, s49, 4
    s_lshl_b32 s53, s52, 257
    v_mfma_f32_16x16x32_bf16 v[116:119], a[148:151], a[132:135], v[116:119]
    buffer_load_dwordx4 v10, s[8:11], s45 offen offset:0 lds
    v_mfma_f32_16x16x32_bf16 v[112:115], a[144:147], a[132:135], v[112:115]
    s_sub_u32 s53, 1, s53
    s_min_u32 s54, s51, 1
    s_xor_b32 s54, s54, 1
    v_mfma_f32_16x16x32_bf16 v[128:131], a[144:147], a[136:139], v[128:131]
    s_mul_i32 s53, s53, s54
    s_add_u32 s53, s53, 2
    s_mul_i32 s7, s53, 114688
    v_mfma_f32_16x16x32_bf16 v[132:135], a[148:151], a[136:139], v[132:135]
    s_lshl2_add_u32 s51, s51, s52
    s_and_b32 s52, s38, 1
    s_lshl1_add_u32 s53, s51, s52
    v_mfma_f32_16x16x32_bf16 v[136:139], a[152:155], a[136:139], v[136:139]
    buffer_load_dwordx4 v11, s[8:11], s45 offen offset:1024 lds
    v_mfma_f32_16x16x32_bf16 v[140:143], a[156:159], a[136:139], v[140:143]
    s_xor_b32 s54, s53, 1
    s_mul_i32 s53, s53, 57344
    s_mul_i32 s54, s54, 57344
    v_mfma_f32_16x16x32_bf16 v[156:159], a[156:159], a[140:143], v[156:159]
    s_add_u32 s5, s53, s55
    s_add_u32 s6, s54, s55
    s_lshr_b32 s53, s38, 1
    v_mfma_f32_16x16x32_bf16 v[152:155], a[152:155], a[140:143], v[152:155]
    s_add_u32 m0, s43, 114688
    s_lshl1_add_u32 s53, s50, s53
    s_lshl_b32 s57, s53, 5
    v_mfma_f32_16x16x32_bf16 v[148:151], a[148:151], a[140:143], v[148:151]
    buffer_load_dwordx4 v19, s[24:27], s46 offen offset:1024 lds
    v_mfma_f32_16x16x32_bf16 v[144:147], a[144:147], a[140:143], v[144:147]
    s_waitcnt vmcnt(17) lgkmcnt(0)
    s_barrier
    v_mfma_f32_16x16x32_bf16 v[32:35], a[96:99], a[64:67], v[32:35]
    ds_read_b64_tr_b16 a[144:145], v14 offset:49152
    s_lshl_b32 s52, s52, 276
    v_mfma_f32_16x16x32_bf16 v[36:39], a[100:103], a[64:67], v[36:39]
    ds_read_b128 a[112:115], v17 offset:0
    s_lshl_b32 s54, s49, 10
    v_mfma_f32_16x16x32_bf16 v[40:43], a[104:107], a[64:67], v[40:43]
    s_add_u32 s52, s52, s54
    s_lshl1_add_u32 s48, s57, s52
    s_add_u32 s39, s48, 32768
    v_mfma_f32_16x16x32_bf16 v[44:47], a[108:111], a[64:67], v[44:47]
    ds_read_b64_tr_b16 a[146:147], v14 offset:53248
    s_sub_u32 s54, 32, s49
    v_mfma_f32_16x16x32_bf16 v[60:63], a[108:111], a[68:71], v[60:63]
    ds_read_b128 a[116:119], v17 offset:8192
    s_and_b32 s54, s54, 31
    v_mfma_f32_16x16x32_bf16 v[56:59], a[104:107], a[68:71], v[56:59]
    ds_read_b64_tr_b16 a[148:149], v15 offset:49152
    s_cmp_ge_u32 s50, 4
    s_cselect_b32 s52, -8, 8
    s_cselect_b32 s54, s54, s49
    v_mfma_f32_16x16x32_bf16 v[52:55], a[100:103], a[68:71], v[52:55]
    s_and_b32 s51, s52, 4096
    s_movk_i32 s53, 2048
    v_and_b32 v220, 15, v0
    v_mfma_f32_16x16x32_bf16 v[48:51], a[96:99], a[68:71], v[48:51]
    ds_read_b128 a[120:123], v17 offset:1024
    v_add_u32_e64 v220, s57, v220
    v_mfma_f32_16x16x32_bf16 v[64:67], a[96:99], a[72:75], v[64:67]
    ds_read_b64_tr_b16 a[150:151], v15 offset:53248
    v_mul_lo_u32 v220, v220, s52
    v_mfma_f32_16x16x32_bf16 v[68:71], a[100:103], a[72:75], v[68:71]
    ds_read_b128 a[124:127], v17 offset:9216
    s_add_u32 m0, s43, 98304
    v_mfma_f32_16x16x32_bf16 v[72:75], a[104:107], a[72:75], v[72:75]
    buffer_load_dwordx4 v12, s[8:11], s45 offen offset:2048 lds
    v_mfma_f32_16x16x32_bf16 v[76:79], a[108:111], a[72:75], v[76:79]
    ds_read_b64_tr_b16 a[152:153], v14 offset:50176
    v_add_u32_e64 v220, s51, v220
    v_mfma_f32_16x16x32_bf16 v[92:95], a[108:111], a[76:79], v[92:95]
    ds_read_b128 a[128:131], v17 offset:2048
    v_lshrrev_b32_e64 v221, 4, v0
    v_mfma_f32_16x16x32_bf16 v[88:91], a[104:107], a[76:79], v[88:91]
    ds_read_b64_tr_b16 a[154:155], v14 offset:54272
    v_mul_u32_u24 v221, 4352, v221
    v_mfma_f32_16x16x32_bf16 v[84:87], a[100:103], a[76:79], v[84:87]
    buffer_load_dwordx4 v13, s[8:11], s45 offen offset:3072 lds
    v_mfma_f32_16x16x32_bf16 v[80:83], a[96:99], a[76:79], v[80:83]
    ds_read_b128 a[132:135], v17 offset:10240
    s_add_u32 m0, s43, 32768
    v_mfma_f32_16x16x32_bf16 v[96:99], a[96:99], a[80:83], v[96:99]
    ds_read_b64_tr_b16 a[156:157], v15 offset:50176
    s_xor_b32 s44, s40, 10
    v_mfma_f32_16x16x32_bf16 v[100:103], a[100:103], a[80:83], v[100:103]
    ds_read_b128 a[136:139], v17 offset:3072
    s_mul_i32 s44, s44, s42
    v_mfma_f32_16x16x32_bf16 v[104:107], a[104:107], a[80:83], v[104:107]
    buffer_load_dwordx4 v8, s[12:15], s44 offen offset:0 lds
    v_mfma_f32_16x16x32_bf16 v[108:111], a[108:111], a[80:83], v[108:111]
    ds_read_b64_tr_b16 a[158:159], v15 offset:54272
    s_lshl_b32 s52, s52, 260
    v_mfma_f32_16x16x32_bf16 v[124:127], a[108:111], a[84:87], v[124:127]
    ds_read_b128 a[140:143], v17 offset:11264
    v_add3_u32 v253, s52, v220, v221
    v_mfma_f32_16x16x32_bf16 v[120:123], a[104:107], a[84:87], v[120:123]
    v_cmp_eq_u32 s[98:99], s53, v220
    v_mfma_f32_16x16x32_bf16 v[116:119], a[100:103], a[84:87], v[116:119]
    buffer_load_dwordx4 v8, s[16:19], s44 offen offset:1024 lds
    v_mfma_f32_16x16x32_bf16 v[112:115], a[96:99], a[84:87], v[112:115]
    s_mul_i32 s51, s54, 34808
    s_sub_u32 s51, 1114112, s51
    v_mov_b32_e64 v252, s51
    v_mfma_f32_16x16x32_bf16 v[128:131], a[96:99], a[88:91], v[128:131]
    v_cndmask_b32 v220, v220, v252, s[98:99]
    v_add_u32_e64 v252, v220, v221
    v_mfma_f32_16x16x32_bf16 v[132:135], a[100:103], a[88:91], v[132:135]
    s_mul_i32 s54, s54, 34816
    s_add_u32 s100, s54, 7471104
    s_add_u32 s101, s54, 7488512
    v_mfma_f32_16x16x32_bf16 v[136:139], a[104:107], a[88:91], v[136:139]
    buffer_load_dwordx4 v9, s[12:15], s44 offen offset:2048 lds
    v_mfma_f32_16x16x32_bf16 v[140:143], a[108:111], a[88:91], v[140:143]
    v_subrev_u32 v220, 32768, v22
    v_subrev_u32 v221, 32768, v23
    v_mfma_f32_16x16x32_bf16 v[156:159], a[108:111], a[92:95], v[156:159]
    v_subrev_u32 v222, 32768, v24
    v_subrev_u32 v223, 32768, v25
    v_mfma_f32_16x16x32_bf16 v[152:155], a[104:107], a[92:95], v[152:155]
    v_mfma_f32_16x16x32_bf16 v[148:151], a[100:103], a[92:95], v[148:151]
    buffer_load_dwordx4 v9, s[16:19], s44 offen offset:3072 lds
    v_mfma_f32_16x16x32_bf16 v[144:147], a[96:99], a[92:95], v[144:147]
    s_waitcnt vmcnt(14) lgkmcnt(0)
    s_barrier
    v_mfma_f32_16x16x32_bf16 v[32:35], a[144:147], a[112:115], v[32:35]
    ds_read_b64_tr_b16 a[96:97], v14 offset:0
    v_mfma_f32_16x16x32_bf16 v[36:39], a[148:151], a[112:115], v[36:39]
    ds_read_b128 a[64:67], v16 offset:16384
    s_add_u32 m0, s43, 147456
    v_mfma_f32_16x16x32_bf16 v[40:43], a[152:155], a[112:115], v[40:43]
    buffer_load_dwordx4 v26, s[20:23], s62 offen offset:0 sc1 lds
    v_mfma_f32_16x16x32_bf16 v[44:47], a[156:159], a[112:115], v[44:47]
    ds_read_b64_tr_b16 a[98:99], v14 offset:4096
    v_mfma_f32_16x16x32_bf16 v[60:63], a[156:159], a[116:119], v[60:63]
    ds_read_b128 a[68:71], v16 offset:24576
    v_mfma_f32_16x16x32_bf16 v[56:59], a[152:155], a[116:119], v[56:59]
    ds_read_b64_tr_b16 a[100:101], v15 offset:0
    v_mfma_f32_16x16x32_bf16 v[52:55], a[148:151], a[116:119], v[52:55]
    buffer_load_dwordx4 v26, s[20:23], s62 offen offset:1024 sc1 lds
    v_mfma_f32_16x16x32_bf16 v[48:51], a[144:147], a[116:119], v[48:51]
    ds_read_b128 a[72:75], v16 offset:17408
    v_mfma_f32_16x16x32_bf16 v[64:67], a[144:147], a[120:123], v[64:67]
    ds_read_b64_tr_b16 a[102:103], v15 offset:4096
    v_mfma_f32_16x16x32_bf16 v[68:71], a[148:151], a[120:123], v[68:71]
    ds_read_b128 a[76:79], v16 offset:25600
    v_mfma_f32_16x16x32_bf16 v[72:75], a[152:155], a[120:123], v[72:75]
    buffer_load_dwordx4 v[192:195], v28, s[20:23], s61 offen offset:0 sc1
    v_mfma_f32_16x16x32_bf16 v[76:79], a[156:159], a[120:123], v[76:79]
    ds_read_b64_tr_b16 a[104:105], v14 offset:1024
    s_add_u32 m0, s43, 49152
    v_mfma_f32_16x16x32_bf16 v[92:95], a[156:159], a[124:127], v[92:95]
k_pad5:
    s_cbranch_execz k_padback
    s_nop 0
    ds_read_b128 a[80:83], v16 offset:18432
    s_xor_b32 s44, s40, 11
    v_mfma_f32_16x16x32_bf16 v[88:91], a[152:155], a[124:127], v[88:91]
    ds_read_b64_tr_b16 a[106:107], v14 offset:5120
    s_mul_i32 s44, s44, s42
    v_mfma_f32_16x16x32_bf16 v[84:87], a[148:151], a[124:127], v[84:87]
    buffer_load_dwordx4 v8, s[12:15], s44 offen offset:0 lds
    v_mfma_f32_16x16x32_bf16 v[80:83], a[144:147], a[124:127], v[80:83]
    ds_read_b128 a[84:87], v16 offset:26624
    v_mfma_f32_16x16x32_bf16 v[96:99], a[144:147], a[128:131], v[96:99]
    ds_read_b64_tr_b16 a[108:109], v15 offset:1024
    v_mfma_f32_16x16x32_bf16 v[100:103], a[148:151], a[128:131], v[100:103]
    ds_read_b128 a[88:91], v16 offset:19456
    v_mfma_f32_16x16x32_bf16 v[104:107], a[152:155], a[128:131], v[104:107]
    buffer_load_dwordx4 v8, s[16:19], s44 offen offset:1024 lds
    v_mfma_f32_16x16x32_bf16 v[108:111], a[156:159], a[128:131], v[108:111]
    ds_read_b64_tr_b16 a[110:111], v15 offset:5120
    v_mfma_f32_16x16x32_bf16 v[124:127], a[156:159], a[132:135], v[124:127]
    ds_read_b128 a[92:95], v16 offset:27648
    v_mfma_f32_16x16x32_bf16 v[120:123], a[152:155], a[132:135], v[120:123]
    v_mfma_f32_16x16x32_bf16 v[116:119], a[148:151], a[132:135], v[116:119]
    buffer_load_dwordx4 v9, s[12:15], s44 offen offset:2048 lds
    v_mfma_f32_16x16x32_bf16 v[112:115], a[144:147], a[132:135], v[112:115]
    v_mfma_f32_16x16x32_bf16 v[128:131], a[144:147], a[136:139], v[128:131]
    v_mfma_f32_16x16x32_bf16 v[132:135], a[148:151], a[136:139], v[132:135]
    v_mfma_f32_16x16x32_bf16 v[136:139], a[152:155], a[136:139], v[136:139]
    buffer_load_dwordx4 v9, s[16:19], s44 offen offset:3072 lds
    v_mfma_f32_16x16x32_bf16 v[140:143], a[156:159], a[136:139], v[140:143]
    v_mfma_f32_16x16x32_bf16 v[156:159], a[156:159], a[140:143], v[156:159]
    s_add_u32 m0, s43, 65536
    v_mfma_f32_16x16x32_bf16 v[152:155], a[152:155], a[140:143], v[152:155]
    s_xor_b32 s45, s41, 768
    v_mfma_f32_16x16x32_bf16 v[148:151], a[148:151], a[140:143], v[148:151]
    buffer_load_dwordx4 v10, s[8:11], s45 offen offset:0 lds
    v_mfma_f32_16x16x32_bf16 v[144:147], a[144:147], a[140:143], v[144:147]
    s_waitcnt vmcnt(17) lgkmcnt(0)
    s_barrier
    v_mfma_f32_16x16x32_bf16 v[32:35], a[96:99], a[64:67], v[32:35]
    ds_read_b64_tr_b16 a[144:145], v14 offset:16384
    v_subrev_u32 v204, 98304, v22
    v_mfma_f32_16x16x32_bf16 v[36:39], a[100:103], a[64:67], v[36:39]
    ds_read_b128 a[112:115], v17 offset:16384
    v_subrev_u32 v205, 98304, v23
    v_mfma_f32_16x16x32_bf16 v[40:43], a[104:107], a[64:67], v[40:43]
    v_subrev_u32 v206, 98304, v24
    v_subrev_u32 v207, 98304, v25
    v_mfma_f32_16x16x32_bf16 v[44:47], a[108:111], a[64:67], v[44:47]
    ds_read_b64_tr_b16 a[146:147], v14 offset:20480
    v_mfma_f32_16x16x32_bf16 v[60:63], a[108:111], a[68:71], v[60:63]
    ds_read_b128 a[116:119], v17 offset:24576
    v_mfma_f32_16x16x32_bf16 v[56:59], a[104:107], a[68:71], v[56:59]
    ds_read_b64_tr_b16 a[148:149], v15 offset:16384
    v_mfma_f32_16x16x32_bf16 v[52:55], a[100:103], a[68:71], v[52:55]
    buffer_load_dwordx4 v11, s[8:11], s45 offen offset:1024 lds
    v_mfma_f32_16x16x32_bf16 v[48:51], a[96:99], a[68:71], v[48:51]
    ds_read_b128 a[120:123], v17 offset:17408
    v_mfma_f32_16x16x32_bf16 v[64:67], a[96:99], a[72:75], v[64:67]
    ds_read_b64_tr_b16 a[150:151], v15 offset:20480
    v_mfma_f32_16x16x32_bf16 v[68:71], a[100:103], a[72:75], v[68:71]
    ds_read_b128 a[124:127], v17 offset:25600
    v_mfma_f32_16x16x32_bf16 v[72:75], a[104:107], a[72:75], v[72:75]
    buffer_load_dwordx4 v12, s[8:11], s45 offen offset:2048 lds
    v_mfma_f32_16x16x32_bf16 v[76:79], a[108:111], a[72:75], v[76:79]
    ds_read_b64_tr_b16 a[152:153], v14 offset:17408
    v_mfma_f32_16x16x32_bf16 v[92:95], a[108:111], a[76:79], v[92:95]
    ds_read_b128 a[128:131], v17 offset:18432
    v_mfma_f32_16x16x32_bf16 v[88:91], a[104:107], a[76:79], v[88:91]
    ds_read_b64_tr_b16 a[154:155], v14 offset:21504
    v_mfma_f32_16x16x32_bf16 v[84:87], a[100:103], a[76:79], v[84:87]
    buffer_load_dwordx4 v13, s[8:11], s45 offen offset:3072 lds
    v_mfma_f32_16x16x32_bf16 v[80:83], a[96:99], a[76:79], v[80:83]
    ds_read_b128 a[132:135], v17 offset:26624
    s_add_u32 m0, s43, 0
    v_mfma_f32_16x16x32_bf16 v[96:99], a[96:99], a[80:83], v[96:99]
    ds_read_b64_tr_b16 a[156:157], v15 offset:17408
    s_xor_b32 s44, s40, 12
    v_mfma_f32_16x16x32_bf16 v[100:103], a[100:103], a[80:83], v[100:103]
    ds_read_b128 a[136:139], v17 offset:19456
    s_mul_i32 s44, s44, s42
    s_nop 0
    v_mfma_f32_16x16x32_bf16 v[104:107], a[104:107], a[80:83], v[104:107]
    buffer_load_dwordx4 v8, s[12:15], s44 offen offset:0 lds
    v_mfma_f32_16x16x32_bf16 v[108:111], a[108:111], a[80:83], v[108:111]
    ds_read_b64_tr_b16 a[158:159], v15 offset:21504
    v_mfma_f32_16x16x32_bf16 v[124:127], a[108:111], a[84:87], v[124:127]
    ds_read_b128 a[140:143], v17 offset:27648
    v_mfma_f32_16x16x32_bf16 v[120:123], a[104:107], a[84:87], v[120:123]
    v_mfma_f32_16x16x32_bf16 v[116:119], a[100:103], a[84:87], v[116:119]
    buffer_load_dwordx4 v8, s[16:19], s44 offen offset:1024 lds
    v_mfma_f32_16x16x32_bf16 v[112:115], a[96:99], a[84:87], v[112:115]
    v_mfma_f32_16x16x32_bf16 v[128:131], a[96:99], a[88:91], v[128:131]
    v_mfma_f32_16x16x32_bf16 v[132:135], a[100:103], a[88:91], v[132:135]
    v_mfma_f32_16x16x32_bf16 v[136:139], a[104:107], a[88:91], v[136:139]
    buffer_load_dwordx4 v9, s[12:15], s44 offen offset:2048 lds
    v_mfma_f32_16x16x32_bf16 v[140:143], a[108:111], a[88:91], v[140:143]
    v_mfma_f32_16x16x32_bf16 v[156:159], a[108:111], a[92:95], v[156:159]
    v_mfma_f32_16x16x32_bf16 v[152:155], a[104:107], a[92:95], v[152:155]
    v_mfma_f32_16x16x32_bf16 v[148:151], a[100:103], a[92:95], v[148:151]
    buffer_load_dwordx4 v9, s[16:19], s44 offen offset:3072 lds
    v_mfma_f32_16x16x32_bf16 v[144:147], a[96:99], a[92:95], v[144:147]
    s_waitcnt vmcnt(8) lgkmcnt(0)
    s_barrier
    v_mfma_f32_16x16x32_bf16 v[32:35], a[144:147], a[112:115], v[32:35]
    s_add_u32 m0, s43, 16384
    s_xor_b32 s44, s40, 13
    v_mfma_f32_16x16x32_bf16 v[36:39], a[148:151], a[112:115], v[36:39]
    ds_read_b64_tr_b16 a[96:97], v14 offset:32768
    s_mul_i32 s44, s44, s42
    v_mfma_f32_16x16x32_bf16 v[40:43], a[152:155], a[112:115], v[40:43]
    buffer_load_dwordx4 v8, s[12:15], s44 offen offset:0 lds
    v_mfma_f32_16x16x32_bf16 v[44:47], a[156:159], a[112:115], v[44:47]
    ds_read_b128 a[64:67], v16 offset:32768
    v_mfma_f32_16x16x32_bf16 v[60:63], a[156:159], a[116:119], v[60:63]
    ds_read_b64_tr_b16 a[98:99], v14 offset:36864
    v_mfma_f32_16x16x32_bf16 v[56:59], a[152:155], a[116:119], v[56:59]
    ds_read_b128 a[68:71], v17 offset:32768
    v_mfma_f32_16x16x32_bf16 v[52:55], a[148:151], a[116:119], v[52:55]
    buffer_load_dwordx4 v8, s[16:19], s44 offen offset:1024 lds
    v_mfma_f32_16x16x32_bf16 v[48:51], a[144:147], a[116:119], v[48:51]
    ds_read_b64_tr_b16 a[100:101], v15 offset:32768
    v_mfma_f32_16x16x32_bf16 v[64:67], a[144:147], a[120:123], v[64:67]
    ds_read_b128 a[72:75], v16 offset:40960
    ds_read_b64_tr_b16 a[160:161], v14 offset:49152
    v_mfma_f32_16x16x32_bf16 v[68:71], a[148:151], a[120:123], v[68:71]
    ds_read_b64_tr_b16 a[102:103], v15 offset:36864
    ds_read_b64_tr_b16 a[162:163], v14 offset:53248
    v_mfma_f32_16x16x32_bf16 v[72:75], a[152:155], a[120:123], v[72:75]
    buffer_load_dwordx4 v9, s[12:15], s44 offen offset:2048 lds
    v_mfma_f32_16x16x32_bf16 v[76:79], a[156:159], a[120:123], v[76:79]
    ds_read_b128 a[76:79], v17 offset:40960
    ds_read_b64_tr_b16 a[164:165], v15 offset:49152
    v_mfma_f32_16x16x32_bf16 v[92:95], a[156:159], a[124:127], v[92:95]
    ds_read_b64_tr_b16 a[104:105], v14 offset:33792
    ds_read_b64_tr_b16 a[166:167], v15 offset:53248
    v_mfma_f32_16x16x32_bf16 v[88:91], a[152:155], a[124:127], v[88:91]
    ds_read_b128 a[80:83], v16 offset:33792
    ds_read_b64_tr_b16 a[168:169], v14 offset:50176
    v_mfma_f32_16x16x32_bf16 v[84:87], a[148:151], a[124:127], v[84:87]
    buffer_load_dwordx4 v9, s[16:19], s44 offen offset:3072 lds
    v_mfma_f32_16x16x32_bf16 v[80:83], a[144:147], a[124:127], v[80:83]
    ds_read_b64_tr_b16 a[106:107], v14 offset:37888
    ds_read_b64_tr_b16 a[170:171], v14 offset:54272
    v_mfma_f32_16x16x32_bf16 v[96:99], a[144:147], a[128:131], v[96:99]
    ds_read_b128 a[84:87], v17 offset:33792
    s_add_u32 m0, s43, 81920
    v_mfma_f32_16x16x32_bf16 v[100:103], a[148:151], a[128:131], v[100:103]
    ds_read_b64_tr_b16 a[108:109], v15 offset:33792
    s_xor_b32 s45, s41, 896
    v_mfma_f32_16x16x32_bf16 v[104:107], a[152:155], a[128:131], v[104:107]
    buffer_load_dwordx4 v10, s[8:11], s45 offen offset:0 lds
    v_mfma_f32_16x16x32_bf16 v[108:111], a[156:159], a[128:131], v[108:111]
    ds_read_b128 a[88:91], v16 offset:41984
    ds_read_b64_tr_b16 a[172:173], v15 offset:50176
    v_mfma_f32_16x16x32_bf16 v[124:127], a[156:159], a[132:135], v[124:127]
    ds_read_b64_tr_b16 a[110:111], v15 offset:37888
    ds_read_b64_tr_b16 a[174:175], v15 offset:54272
    v_mfma_f32_16x16x32_bf16 v[120:123], a[152:155], a[132:135], v[120:123]
    ds_read_b128 a[92:95], v17 offset:41984
    s_waitcnt vmcnt(17)
    v_mfma_f32_16x16x32_bf16 v[116:119], a[148:151], a[132:135], v[116:119]
    buffer_load_dwordx4 v11, s[8:11], s45 offen offset:1024 lds
    v_mfma_f32_16x16x32_bf16 v[112:115], a[144:147], a[132:135], v[112:115]
    ds_read_b128 v[244:247], v7 offset:0
    v_mfma_f32_16x16x32_bf16 v[128:131], a[144:147], a[136:139], v[128:131]
    ds_read_b128 v[248:251], v7 offset:1024
    v_mfma_f32_16x16x32_bf16 v[132:135], a[148:151], a[136:139], v[132:135]
    v_mfma_f32_16x16x32_bf16 v[136:139], a[152:155], a[136:139], v[136:139]
    buffer_load_dwordx4 v12, s[8:11], s45 offen offset:2048 lds
    v_mfma_f32_16x16x32_bf16 v[140:143], a[156:159], a[136:139], v[140:143]
    v_mfma_f32_16x16x32_bf16 v[156:159], a[156:159], a[140:143], v[156:159]
    v_mfma_f32_16x16x32_bf16 v[152:155], a[152:155], a[140:143], v[152:155]
    s_waitcnt lgkmcnt(0)
    v_max3_u32 v30, v195, v194, v193
    v_max3_u32 v30, v30, v192, v251
    v_mfma_f32_16x16x32_bf16 v[148:151], a[148:151], a[140:143], v[148:151]
    buffer_load_dwordx4 v13, s[8:11], s45 offen offset:3072 lds
    v_mfma_f32_16x16x32_bf16 v[144:147], a[144:147], a[140:143], v[144:147]
    s_waitcnt vmcnt(8) lgkmcnt(2)
    s_barrier
    v_mfma_f32_16x16x32_bf16 v[32:35], a[96:99], a[64:67], v[32:35]
    s_add_u32 m0, s43, 32768
    s_xor_b32 s44, s40, 14
    v_max3_u32 v30, v30, v250, v249
    v_mfma_f32_16x16x32_bf16 v[32:35], a[160:163], a[68:71], v[32:35]
    ds_read_b64_tr_b16 a[144:145], v14 offset:0
    s_mul_i32 s44, s44, s42
    v_mfma_f32_16x16x32_bf16 v[36:39], a[164:167], a[68:71], v[36:39]
    buffer_load_dwordx4 v8, s[12:15], s44 offen offset:0 lds
    v_mfma_f32_16x16x32_bf16 v[36:39], a[100:103], a[64:67], v[36:39]
    ds_read_b128 a[112:115], v16 offset:34816
    v_max3_u32 v30, v30, v248, v247
    v_mfma_f32_16x16x32_bf16 v[40:43], a[104:107], a[64:67], v[40:43]
    ds_read_b64_tr_b16 a[146:147], v14 offset:4096
    v_max3_u32 v30, v30, v246, v245
    v_mfma_f32_16x16x32_bf16 v[40:43], a[168:171], a[68:71], v[40:43]
    ds_read_b128 a[116:119], v17 offset:34816
    v_max_u32_e64 v30, v30, v244
    v_mfma_f32_16x16x32_bf16 v[44:47], a[172:175], a[68:71], v[44:47]
    buffer_load_dwordx4 v8, s[16:19], s44 offen offset:1024 lds
    v_mfma_f32_16x16x32_bf16 v[44:47], a[108:111], a[64:67], v[44:47]
    ds_read_b64_tr_b16 a[148:149], v15 offset:0
    v_cmp_eq_u32 vcc, -1, v30
    v_mfma_f32_16x16x32_bf16 v[60:63], a[108:111], a[72:75], v[60:63]
    ds_read_b128 a[120:123], v16 offset:43008
    s_cbranch_vccnz fg_spin
fg_back:
    v_mfma_f32_16x16x32_bf16 v[60:63], a[172:175], a[76:79], v[60:63]
    ds_read_b64_tr_b16 a[150:151], v15 offset:4096
    ds_read_b128 v[160:163], v6 offset:0
    v_mfma_f32_16x16x32_bf16 v[56:59], a[168:171], a[76:79], v[56:59]
    buffer_load_dwordx4 v9, s[12:15], s44 offen offset:2048 lds
    v_mfma_f32_16x16x32_bf16 v[56:59], a[104:107], a[72:75], v[56:59]
    ds_read_b128 a[124:127], v17 offset:43008
    ds_read_b128 v[164:167], v6 offset:256
    v_mfma_f32_16x16x32_bf16 v[52:55], a[100:103], a[72:75], v[52:55]
    ds_read_b64_tr_b16 a[152:153], v14 offset:1024
    ds_read_b128 v[168:171], v6 offset:512
    v_mfma_f32_16x16x32_bf16 v[52:55], a[164:167], a[76:79], v[52:55]
    ds_read_b128 a[128:131], v16 offset:35840
    ds_read_b128 v[172:175], v6 offset:768
    v_mfma_f32_16x16x32_bf16 v[48:51], a[160:163], a[76:79], v[48:51]
    buffer_load_dwordx4 v9, s[16:19], s44 offen offset:3072 lds
    v_mfma_f32_16x16x32_bf16 v[48:51], a[96:99], a[72:75], v[48:51]
    ds_read_b64_tr_b16 a[154:155], v14 offset:5120
    s_add_u32 m0, s43, 49152
    v_mfma_f32_16x16x32_bf16 v[64:67], a[96:99], a[80:83], v[64:67]
    ds_read_b128 a[132:135], v17 offset:35840
    s_xor_b32 s44, s40, 15
    v_mfma_f32_16x16x32_bf16 v[64:67], a[160:163], a[84:87], v[64:67]
    ds_read_b64_tr_b16 a[156:157], v15 offset:1024
    s_mul_i32 s44, s44, s42
    v_mfma_f32_16x16x32_bf16 v[68:71], a[164:167], a[84:87], v[68:71]
    buffer_load_dwordx4 v8, s[12:15], s44 offen offset:0 lds
    v_mfma_f32_16x16x32_bf16 v[68:71], a[100:103], a[80:83], v[68:71]
    ds_read_b128 a[136:139], v16 offset:44032
    ds_read_b128 v[176:179], v6 offset:1024
    v_mfma_f32_16x16x32_bf16 v[72:75], a[104:107], a[80:83], v[72:75]
    ds_read_b64_tr_b16 a[158:159], v15 offset:5120
    ds_read_b128 v[180:183], v6 offset:1280
    v_mfma_f32_16x16x32_bf16 v[72:75], a[168:171], a[84:87], v[72:75]
    ds_read_b128 a[140:143], v17 offset:44032
    ds_read_b128 v[184:187], v6 offset:1536
    v_mfma_f32_16x16x32_bf16 v[76:79], a[172:175], a[84:87], v[76:79]
    buffer_load_dwordx4 v8, s[16:19], s44 offen offset:1024 lds
    v_mfma_f32_16x16x32_bf16 v[76:79], a[108:111], a[80:83], v[76:79]
    ds_read_b128 v[188:191], v6 offset:1792
    v_add_f32_dpp v192, v192, v192 quad_perm:[1,0,3,2] row_mask:0xf bank_mask:0xf
    v_mfma_f32_16x16x32_bf16 v[92:95], a[108:111], a[88:91], v[92:95]
    s_mul_i32 s4, s36, 462848
    v_add_f32_dpp v193, v193, v193 quad_perm:[1,0,3,2] row_mask:0xf bank_mask:0xf
    v_add_f32_dpp v194, v194, v194 quad_perm:[1,0,3,2] row_mask:0xf bank_mask:0xf
    v_mfma_f32_16x16x32_bf16 v[92:95], a[172:175], a[92:95], v[92:95]
    s_lshl2_add_u32 s52, s37, s38
    v_add_f32_dpp v195, v195, v195 quad_perm:[1,0,3,2] row_mask:0xf bank_mask:0xf
    v_add_f32_dpp v192, v192, v192 quad_perm:[2,3,0,1] row_mask:0xf bank_mask:0xf
    v_mfma_f32_16x16x32_bf16 v[88:91], a[168:171], a[92:95], v[88:91]
    buffer_load_dwordx4 v9, s[12:15], s44 offen offset:2048 lds
    v_mfma_f32_16x16x32_bf16 v[88:91], a[104:107], a[88:91], v[88:91]
    s_lshl_b32 s53, s52, 10
    v_add_f32_dpp v193, v193, v193 quad_perm:[2,3,0,1] row_mask:0xf bank_mask:0xf
    v_add_f32_dpp v194, v194, v194 quad_perm:[2,3,0,1] row_mask:0xf bank_mask:0xf
    v_mfma_f32_16x16x32_bf16 v[84:87], a[100:103], a[88:91], v[84:87]
    s_waitcnt lgkmcnt(0)
    s_add_u32 s4, s4, s53
    v_add_f32_dpp v195, v195, v195 quad_perm:[2,3,0,1] row_mask:0xf bank_mask:0xf
    v_mfma_f32_16x16x32_bf16 v[84:87], a[164:167], a[92:95], v[84:87]
    v_mfma_f32_16x16x32_bf16 v[80:83], a[160:163], a[92:95], v[80:83]
    buffer_load_dwordx4 v9, s[16:19], s44 offen offset:3072 lds
    v_mfma_f32_16x16x32_bf16 v[80:83], a[96:99], a[88:91], v[80:83]
    s_waitcnt vmcnt(12) lgkmcnt(2)
    s_barrier
    v_mfma_f32_16x16x32_bf16 v[96:99], a[96:99], a[112:115], v[96:99]
    ds_read_b64_tr_b16 a[176:177], v14 offset:16384
    v_fmac_f32_dpp v32, v192, v160 row_newbcast:0 row_mask:0xf bank_mask:0xf
    v_mfma_f32_16x16x32_bf16 v[96:99], a[160:163], a[116:119], v[96:99]
    ds_read_b128 a[64:67], v16 offset:0
    s_add_u32 m0, s43, 114688
    v_mfma_f32_16x16x32_bf16 v[100:103], a[164:167], a[116:119], v[100:103]
    buffer_load_dwordx4 v20, s[24:27], s46 offen offset:2048 lds
    v_mfma_f32_16x16x32_bf16 v[100:103], a[100:103], a[112:115], v[100:103]
    ds_read_b64_tr_b16 a[178:179], v14 offset:20480
    v_fmac_f32_dpp v33, v193, v160 row_newbcast:0 row_mask:0xf bank_mask:0xf
    v_mfma_f32_16x16x32_bf16 v[104:107], a[104:107], a[112:115], v[104:107]
    ds_read_b128 a[68:71], v17 offset:0
    v_fmac_f32_dpp v34, v194, v160 row_newbcast:0 row_mask:0xf bank_mask:0xf
    v_mfma_f32_16x16x32_bf16 v[104:107], a[168:171], a[116:119], v[104:107]
    ds_read_b64_tr_b16 a[180:181], v15 offset:16384
    v_fmac_f32_dpp v35, v195, v160 row_newbcast:0 row_mask:0xf bank_mask:0xf
    v_mfma_f32_16x16x32_bf16 v[108:111], a[172:175], a[116:119], v[108:111]
    buffer_load_dwordx4 v21, s[24:27], s46 offen offset:3072 lds
    v_mfma_f32_16x16x32_bf16 v[108:111], a[108:111], a[112:115], v[108:111]
    ds_read_b128 a[72:75], v16 offset:8192
    v_fmac_f32_dpp v36, v192, v160 row_newbcast:4 row_mask:0xf bank_mask:0xf
    v_mfma_f32_16x16x32_bf16 v[124:127], a[108:111], a[120:123], v[124:127]
    ds_read_b64_tr_b16 a[182:183], v15 offset:20480
    s_add_u32 m0, s43, 131072
    v_mfma_f32_16x16x32_bf16 v[124:127], a[172:175], a[124:127], v[124:127]
    ds_read_b128 a[76:79], v17 offset:8192
    s_lshl_b32 s46, s65, 261
    v_mfma_f32_16x16x32_bf16 v[120:123], a[168:171], a[124:127], v[120:123]
    buffer_load_dwordx4 v18, s[24:27], s46 offen offset:0 lds
    v_mfma_f32_16x16x32_bf16 v[120:123], a[104:107], a[120:123], v[120:123]
    ds_read_b64_tr_b16 a[184:185], v14 offset:17408
    v_fmac_f32_dpp v37, v193, v160 row_newbcast:4 row_mask:0xf bank_mask:0xf
    v_mfma_f32_16x16x32_bf16 v[116:119], a[100:103], a[120:123], v[116:119]
    ds_read_b128 a[80:83], v16 offset:1024
    v_fmac_f32_dpp v38, v194, v160 row_newbcast:4 row_mask:0xf bank_mask:0xf
    v_mfma_f32_16x16x32_bf16 v[116:119], a[164:167], a[124:127], v[116:119]
    ds_read_b64_tr_b16 a[186:187], v14 offset:21504
    v_fmac_f32_dpp v39, v195, v160 row_newbcast:4 row_mask:0xf bank_mask:0xf
    v_mfma_f32_16x16x32_bf16 v[112:115], a[160:163], a[124:127], v[112:115]
    buffer_load_dwordx4 v19, s[24:27], s46 offen offset:1024 lds
    v_mfma_f32_16x16x32_bf16 v[112:115], a[96:99], a[120:123], v[112:115]
    ds_read_b128 a[84:87], v17 offset:1024
    v_fmac_f32_dpp v40, v192, v160 row_newbcast:8 row_mask:0xf bank_mask:0xf
    v_mfma_f32_16x16x32_bf16 v[128:131], a[96:99], a[128:131], v[128:131]
    ds_read_b64_tr_b16 a[188:189], v15 offset:17408
    v_fmac_f32_dpp v41, v193, v160 row_newbcast:8 row_mask:0xf bank_mask:0xf
    v_mfma_f32_16x16x32_bf16 v[128:131], a[160:163], a[132:135], v[128:131]
    ds_read_b128 a[88:91], v16 offset:9216
    v_fmac_f32_dpp v42, v194, v160 row_newbcast:8 row_mask:0xf bank_mask:0xf
    v_mfma_f32_16x16x32_bf16 v[132:135], a[164:167], a[132:135], v[132:135]
    buffer_load_dwordx4 v20, s[24:27], s46 offen offset:2048 lds
    v_mfma_f32_16x16x32_bf16 v[132:135], a[100:103], a[128:131], v[132:135]
    ds_read_b64_tr_b16 a[190:191], v15 offset:21504
    v_fmac_f32_dpp v43, v195, v160 row_newbcast:8 row_mask:0xf bank_mask:0xf
    v_mfma_f32_16x16x32_bf16 v[136:139], a[104:107], a[128:131], v[136:139]
    ds_read_b128 a[92:95], v17 offset:9216
    v_fmac_f32_dpp v44, v192, v160 row_newbcast:12 row_mask:0xf bank_mask:0xf
    v_mfma_f32_16x16x32_bf16 v[136:139], a[168:171], a[132:135], v[136:139]
    v_fmac_f32_dpp v45, v193, v160 row_newbcast:12 row_mask:0xf bank_mask:0xf
    v_fmac_f32_dpp v46, v194, v160 row_newbcast:12 row_mask:0xf bank_mask:0xf
    v_mfma_f32_16x16x32_bf16 v[140:143], a[172:175], a[132:135], v[140:143]
    buffer_load_dwordx4 v21, s[24:27], s46 offen offset:3072 lds
    v_mfma_f32_16x16x32_bf16 v[140:143], a[108:111], a[128:131], v[140:143]
    v_fmac_f32_dpp v47, v195, v160 row_newbcast:12 row_mask:0xf bank_mask:0xf
    v_fmac_f32_dpp v48, v192, v164 row_newbcast:0 row_mask:0xf bank_mask:0xf
    v_mfma_f32_16x16x32_bf16 v[156:159], a[108:111], a[136:139], v[156:159]
    s_add_u32 m0, s43, 98304
    v_fmac_f32_dpp v49, v193, v164 row_newbcast:0 row_mask:0xf bank_mask:0xf
    v_fmac_f32_dpp v50, v194, v164 row_newbcast:0 row_mask:0xf bank_mask:0xf
    v_mfma_f32_16x16x32_bf16 v[156:159], a[172:175], a[140:143], v[156:159]
    s_lshl_b32 s46, s66, 261
    v_fmac_f32_dpp v51, v195, v164 row_newbcast:0 row_mask:0xf bank_mask:0xf
    v_fmac_f32_dpp v52, v192, v164 row_newbcast:4 row_mask:0xf bank_mask:0xf
    v_mfma_f32_16x16x32_bf16 v[152:155], a[168:171], a[140:143], v[152:155]
    buffer_load_dwordx4 v18, s[24:27], s46 offen offset:0 lds
    v_mfma_f32_16x16x32_bf16 v[152:155], a[104:107], a[136:139], v[152:155]
    v_fmac_f32_dpp v53, v193, v164 row_newbcast:4 row_mask:0xf bank_mask:0xf
    v_fmac_f32_dpp v54, v194, v164 row_newbcast:4 row_mask:0xf bank_mask:0xf
    v_mfma_f32_16x16x32_bf16 v[148:151], a[100:103], a[136:139], v[148:151]
    v_fmac_f32_dpp v55, v195, v164 row_newbcast:4 row_mask:0xf bank_mask:0xf
    v_fmac_f32_dpp v56, v192, v164 row_newbcast:8 row_mask:0xf bank_mask:0xf
    v_mfma_f32_16x16x32_bf16 v[148:151], a[164:167], a[140:143], v[148:151]
    v_fmac_f32_dpp v57, v193, v164 row_newbcast:8 row_mask:0xf bank_mask:0xf
    v_fmac_f32_dpp v58, v194, v164 row_newbcast:8 row_mask:0xf bank_mask:0xf
    v_mfma_f32_16x16x32_bf16 v[144:147], a[160:163], a[140:143], v[144:147]
    v_fmac_f32_dpp v59, v195, v164 row_newbcast:8 row_mask:0xf bank_mask:0xf
    v_fmac_f32_dpp v60, v192, v164 row_newbcast:12 row_mask:0xf bank_mask:0xf
    v_mfma_f32_16x16x32_bf16 v[144:147], a[96:99], a[136:139], v[144:147]
    s_waitcnt vmcnt(7) lgkmcnt(0)
    s_barrier
    v_mfma_f32_16x16x32_bf16 v[32:35], a[144:147], a[64:67], v[32:35]
    ds_read_b64_tr_b16 a[96:97], v14 offset:32768
    v_add_u32_e64 v8, s5, v26
    v_mfma_f32_16x16x32_bf16 v[32:35], a[176:179], a[68:71], v[32:35]
    ds_read_b128 a[112:115], v16 offset:16384
    v_add_u32_e64 v9, s6, v26
    v_mfma_f32_16x16x32_bf16 v[36:39], a[180:183], a[68:71], v[36:39]
    buffer_load_dwordx4 v19, s[24:27], s46 offen offset:1024 lds
    v_mfma_f32_16x16x32_bf16 v[36:39], a[148:151], a[64:67], v[36:39]
    ds_read_b64_tr_b16 a[98:99], v14 offset:36864
    v_add_u32_e64 v10, s7, v8
    v_mfma_f32_16x16x32_bf16 v[40:43], a[152:155], a[64:67], v[40:43]
    ds_read_b128 a[116:119], v17 offset:16384
    v_add_u32_e64 v11, s7, v9
    v_mfma_f32_16x16x32_bf16 v[40:43], a[184:187], a[68:71], v[40:43]
    ds_read_b64_tr_b16 a[100:101], v15 offset:32768
    v_bfe_u32 v12, v0, 4, 1
    v_mfma_f32_16x16x32_bf16 v[44:47], a[188:191], a[68:71], v[44:47]
    buffer_load_dwordx4 v20, s[24:27], s46 offen offset:2048 lds
    v_mfma_f32_16x16x32_bf16 v[44:47], a[156:159], a[64:67], v[44:47]
    ds_read_b128 a[120:123], v16 offset:24576
    v_lshrrev_b32_e64 v13, 5, v0
    v_mfma_f32_16x16x32_bf16 v[60:63], a[156:159], a[72:75], v[60:63]
    ds_read_b64_tr_b16 a[102:103], v15 offset:36864
    ds_read_b64_tr_b16 a[160:161], v14 offset:49152
    v_mfma_f32_16x16x32_bf16 v[60:63], a[188:191], a[76:79], v[60:63]
    ds_read_b128 a[124:127], v17 offset:24576
    ds_read_b64_tr_b16 a[162:163], v14 offset:53248
    v_mfma_f32_16x16x32_bf16 v[56:59], a[184:187], a[76:79], v[56:59]
    buffer_load_dwordx4 v21, s[24:27], s46 offen offset:3072 lds
    v_mfma_f32_16x16x32_bf16 v[56:59], a[152:155], a[72:75], v[56:59]
    ds_read_b64_tr_b16 a[104:105], v14 offset:33792
    ds_read_b64_tr_b16 a[164:165], v15 offset:49152
    v_mfma_f32_16x16x32_bf16 v[52:55], a[148:151], a[72:75], v[52:55]
    ds_read_b128 a[128:131], v16 offset:17408
    s_add_u32 m0, s43, 147456
    v_mfma_f32_16x16x32_bf16 v[52:55], a[180:183], a[76:79], v[52:55]
    ds_read_b64_tr_b16 a[106:107], v14 offset:37888
    s_lshl_b32 s46, s67, 261
    v_mfma_f32_16x16x32_bf16 v[48:51], a[176:179], a[76:79], v[48:51]
    buffer_load_dwordx4 v18, s[24:27], s46 offen offset:0 lds
    v_mfma_f32_16x16x32_bf16 v[48:51], a[144:147], a[72:75], v[48:51]
    ds_read_b128 a[132:135], v17 offset:17408
    ds_read_b64_tr_b16 a[166:167], v15 offset:53248
    v_mfma_f32_16x16x32_bf16 v[64:67], a[144:147], a[80:83], v[64:67]
    ds_read_b64_tr_b16 a[108:109], v15 offset:33792
    ds_read_b64_tr_b16 a[168:169], v14 offset:50176
    v_mfma_f32_16x16x32_bf16 v[64:67], a[176:179], a[84:87], v[64:67]
    ds_read_b128 a[136:139], v16 offset:25600
    ds_read_b64_tr_b16 a[170:171], v14 offset:54272
    v_mfma_f32_16x16x32_bf16 v[68:71], a[180:183], a[84:87], v[68:71]
    buffer_load_dwordx4 v19, s[24:27], s46 offen offset:1024 lds
    v_mfma_f32_16x16x32_bf16 v[68:71], a[148:151], a[80:83], v[68:71]
    ds_read_b64_tr_b16 a[110:111], v15 offset:37888
    ds_read_b64_tr_b16 a[172:173], v15 offset:50176
    v_mfma_f32_16x16x32_bf16 v[72:75], a[152:155], a[80:83], v[72:75]
    ds_read_b128 a[140:143], v17 offset:25600
    ds_read_b64_tr_b16 a[174:175], v15 offset:54272
    v_mfma_f32_16x16x32_bf16 v[72:75], a[184:187], a[84:87], v[72:75]
    v_lshl_add_u32 v12, v12, 1, v13
    v_and_b32_e64 v13, 15, v0
    v_mfma_f32_16x16x32_bf16 v[76:79], a[188:191], a[84:87], v[76:79]
    buffer_load_dwordx4 v20, s[24:27], s46 offen offset:2048 lds
    v_mfma_f32_16x16x32_bf16 v[76:79], a[156:159], a[80:83], v[76:79]
    s_waitcnt vmcnt(11)
    v_lshl_add_u32 v12, v13, 12, v12
    v_lshlrev_b32 v12, 4, v12
    v_mfma_f32_16x16x32_bf16 v[92:95], a[156:159], a[88:91], v[92:95]
    ds_read_b64_tr_b16 a[0:1], v22 offset:16384
    v_fmac_f32_dpp v61, v193, v164 row_newbcast:12 row_mask:0xf bank_mask:0xf
    v_mfma_f32_16x16x32_bf16 v[92:95], a[188:191], a[92:95], v[92:95]
    ds_read_b64_tr_b16 a[2:3], v22 offset:18432
    v_fmac_f32_dpp v62, v194, v164 row_newbcast:12 row_mask:0xf bank_mask:0xf
    v_mfma_f32_16x16x32_bf16 v[88:91], a[184:187], a[92:95], v[88:91]
    buffer_load_dwordx4 v21, s[24:27], s46 offen offset:3072 lds
    v_mfma_f32_16x16x32_bf16 v[88:91], a[152:155], a[88:91], v[88:91]
    ds_read_b64_tr_b16 a[4:5], v23 offset:16384
    v_fmac_f32_dpp v63, v195, v164 row_newbcast:12 row_mask:0xf bank_mask:0xf
    v_mfma_f32_16x16x32_bf16 v[84:87], a[148:151], a[88:91], v[84:87]
    ds_read_b64_tr_b16 a[6:7], v23 offset:18432
    s_add_u32 m0, s43, 0
    v_mfma_f32_16x16x32_bf16 v[84:87], a[180:183], a[92:95], v[84:87]
    ds_read_b64_tr_b16 a[8:9], v24 offset:16384
    s_lshl_b32 s46, s68, 5
    v_mfma_f32_16x16x32_bf16 v[80:83], a[176:179], a[92:95], v[80:83]
    buffer_load_dwordx4 v18, s[24:27], s46 offen offset:0 lds
    v_mfma_f32_16x16x32_bf16 v[80:83], a[144:147], a[88:91], v[80:83]
    s_waitcnt vmcnt(35) lgkmcnt(5)
    s_barrier
    v_mfma_f32_16x16x32_bf16 v[32:35], a[96:99], a[112:115], v[32:35]
    ds_read_b128 a[64:67], v16 offset:2048
    v_fmac_f32_dpp v64, v192, v168 row_newbcast:0 row_mask:0xf bank_mask:0xf
    v_mfma_f32_16x16x32_bf16 v[32:35], a[160:163], a[116:119], v[32:35]
    ds_read_b128 a[68:71], v17 offset:2048
    v_fmac_f32_dpp v65, v193, v168 row_newbcast:0 row_mask:0xf bank_mask:0xf
    v_mfma_f32_16x16x32_bf16 v[36:39], a[164:167], a[116:119], v[36:39]
    buffer_load_dwordx4 v19, s[24:27], s46 offen offset:1024 lds
    v_mfma_f32_16x16x32_bf16 v[36:39], a[100:103], a[112:115], v[36:39]
    ds_read_b128 a[72:75], v16 offset:10240
    v_fmac_f32_dpp v66, v194, v168 row_newbcast:0 row_mask:0xf bank_mask:0xf
    v_mfma_f32_16x16x32_bf16 v[40:43], a[104:107], a[112:115], v[40:43]
    ds_read_b128 a[76:79], v17 offset:10240
    v_fmac_f32_dpp v67, v195, v168 row_newbcast:0 row_mask:0xf bank_mask:0xf
    v_mfma_f32_16x16x32_bf16 v[40:43], a[168:171], a[116:119], v[40:43]
    ds_read_b128 a[80:83], v16 offset:3072
    v_fmac_f32_dpp v68, v192, v168 row_newbcast:4 row_mask:0xf bank_mask:0xf
    v_mfma_f32_16x16x32_bf16 v[44:47], a[172:175], a[116:119], v[44:47]
    buffer_load_dwordx4 v20, s[24:27], s46 offen offset:2048 lds
    v_mfma_f32_16x16x32_bf16 v[44:47], a[108:111], a[112:115], v[44:47]
    ds_read_b128 a[84:87], v17 offset:3072
    s_waitcnt vmcnt(11)
    s_nop 0
    v_mfma_f32_16x16x32_bf16 v[60:63], a[108:111], a[120:123], v[60:63]
    ds_read_b128 a[88:91], v16 offset:11264
    v_fmac_f32_dpp v69, v193, v168 row_newbcast:4 row_mask:0xf bank_mask:0xf
    v_mfma_f32_16x16x32_bf16 v[60:63], a[172:175], a[124:127], v[60:63]
    ds_read_b128 a[92:95], v17 offset:11264
    v_fmac_f32_dpp v70, v194, v168 row_newbcast:4 row_mask:0xf bank_mask:0xf
    v_mfma_f32_16x16x32_bf16 v[56:59], a[168:171], a[124:127], v[56:59]
    buffer_load_dwordx4 v21, s[24:27], s46 offen offset:3072 lds
    v_mfma_f32_16x16x32_bf16 v[56:59], a[104:107], a[120:123], v[56:59]
    ds_read_b64_tr_b16 a[10:11], v24 offset:18432
    v_fmac_f32_dpp v71, v195, v168 row_newbcast:4 row_mask:0xf bank_mask:0xf
    v_mfma_f32_16x16x32_bf16 v[52:55], a[100:103], a[120:123], v[52:55]
    ds_read_b64_tr_b16 a[12:13], v25 offset:16384
    s_add_u32 m0, s43, 16384
    v_mfma_f32_16x16x32_bf16 v[52:55], a[164:167], a[124:127], v[52:55]
    ds_read_b64_tr_b16 a[14:15], v25 offset:18432
    s_lshl_b32 s46, s69, 261
    v_mfma_f32_16x16x32_bf16 v[48:51], a[160:163], a[124:127], v[48:51]
    buffer_load_dwordx4 v18, s[24:27], s46 offen offset:0 lds
    v_mfma_f32_16x16x32_bf16 v[48:51], a[96:99], a[120:123], v[48:51]
    ds_read_b64_tr_b16 a[16:17], v22 offset:32768
    v_fmac_f32_dpp v72, v192, v168 row_newbcast:8 row_mask:0xf bank_mask:0xf
    v_mfma_f32_16x16x32_bf16 v[64:67], a[96:99], a[128:131], v[64:67]
    ds_read_b64_tr_b16 a[18:19], v22 offset:34816
    v_fmac_f32_dpp v73, v193, v168 row_newbcast:8 row_mask:0xf bank_mask:0xf
    v_mfma_f32_16x16x32_bf16 v[64:67], a[160:163], a[132:135], v[64:67]
    ds_read_b64_tr_b16 a[20:21], v23 offset:32768
    v_fmac_f32_dpp v76, v192, v168 row_newbcast:12 row_mask:0xf bank_mask:0xf
    v_mfma_f32_16x16x32_bf16 v[68:71], a[164:167], a[132:135], v[68:71]
    buffer_load_dwordx4 v19, s[24:27], s46 offen offset:1024 lds
    v_mfma_f32_16x16x32_bf16 v[68:71], a[100:103], a[128:131], v[68:71]
    ds_read_b64_tr_b16 a[22:23], v23 offset:34816
    s_waitcnt lgkmcnt(4)
    s_nop 0
    v_mfma_f32_16x16x32_bf16 v[72:75], a[104:107], a[128:131], v[72:75]
    ds_read_b64_tr_b16 a[24:25], v24 offset:32768
    v_fmac_f32_dpp v80, v192, v172 row_newbcast:0 row_mask:0xf bank_mask:0xf
    v_mfma_f32_16x16x32_bf16 v[72:75], a[168:171], a[132:135], v[72:75]
    ds_read_b64_tr_b16 a[26:27], v24 offset:34816
    v_fmac_f32_dpp v81, v193, v172 row_newbcast:0 row_mask:0xf bank_mask:0xf
    v_mfma_f32_16x16x32_bf16 v[76:79], a[172:175], a[132:135], v[76:79]
    buffer_load_dwordx4 v20, s[24:27], s46 offen offset:2048 lds
    v_mfma_f32_16x16x32_bf16 v[76:79], a[108:111], a[128:131], v[76:79]
    ds_read_b64_tr_b16 a[28:29], v25 offset:32768
    v_fmac_f32_dpp v82, v194, v172 row_newbcast:0 row_mask:0xf bank_mask:0xf
    v_mfma_f32_16x16x32_bf16 v[92:95], a[108:111], a[136:139], v[92:95]
    ds_read_b64_tr_b16 a[30:31], v25 offset:34816
    v_fmac_f32_dpp v83, v195, v172 row_newbcast:0 row_mask:0xf bank_mask:0xf
    v_mfma_f32_16x16x32_bf16 v[92:95], a[172:175], a[140:143], v[92:95]
    v_fmac_f32_dpp v96, v192, v176 row_newbcast:0 row_mask:0xf bank_mask:0xf
    v_fmac_f32_dpp v97, v193, v176 row_newbcast:0 row_mask:0xf bank_mask:0xf
    v_mfma_f32_16x16x32_bf16 v[88:91], a[168:171], a[140:143], v[88:91]
    buffer_load_dwordx4 v21, s[24:27], s46 offen offset:3072 lds
    v_mfma_f32_16x16x32_bf16 v[88:91], a[104:107], a[136:139], v[88:91]
    s_waitcnt vmcnt(12)
    v_fmac_f32_dpp v98, v194, v176 row_newbcast:0 row_mask:0xf bank_mask:0xf
    v_fmac_f32_dpp v99, v195, v176 row_newbcast:0 row_mask:0xf bank_mask:0xf
    v_mfma_f32_16x16x32_bf16 v[84:87], a[100:103], a[136:139], v[84:87]
    ds_read_b64_tr_b16 a[32:33], v22 offset:0
k_pad6:
    s_cbranch_execz k_padback
    s_nop 0
    s_add_u32 m0, s43, 32768
    v_mfma_f32_16x16x32_bf16 v[84:87], a[164:167], a[140:143], v[84:87]
    ds_read_b64_tr_b16 a[34:35], v22 offset:2048
    s_lshl_b32 s46, s70, 5
    v_mfma_f32_16x16x32_bf16 v[80:83], a[160:163], a[140:143], v[80:83]
    buffer_load_dwordx4 v18, s[24:27], s46 offen offset:0 lds
    v_mfma_f32_16x16x32_bf16 v[80:83], a[96:99], a[136:139], v[80:83]
    s_waitcnt vmcnt(31) lgkmcnt(13)
    s_barrier
    .p2align 3
    v_pk_mul_f32 v[224:225], v[32:33], v[162:163] op_sel_hi:[1,0]
    v_pk_mul_f32 v[226:227], v[34:35], v[162:163] op_sel_hi:[1,0]
    v_pk_mul_f32 v[228:229], v[36:37], v[162:163] op_sel_hi:[1,0]
    v_pk_mul_f32 v[230:231], v[38:39], v[162:163] op_sel_hi:[1,0]
    buffer_load_dwordx4 v19, s[24:27], s46 offen offset:1024 lds
    v_exp_f32 v224, v224
    v_exp_f32 v225, v225
    v_exp_f32 v226, v226
    v_exp_f32 v227, v227
    v_exp_f32 v228, v228
    v_exp_f32 v229, v229
    v_exp_f32 v230, v230
    v_exp_f32 v231, v231
    buffer_load_dwordx4 v20, s[24:27], s46 offen offset:2048 lds
    v_pk_mul_f32 v[32:33], v[32:33], v[40:41]
    v_pk_mul_f32 v[34:35], v[34:35], v[42:43]
    v_pk_mul_f32 v[36:37], v[36:37], v[44:45]
    v_pk_mul_f32 v[38:39], v[38:39], v[46:47]
    v_pk_fma_f32 v[224:225], v[224:225], v[160:161], v[160:161] op_sel:[0,1,1]
    v_pk_fma_f32 v[226:227], v[226:227], v[160:161], v[160:161] op_sel:[0,1,1]
    v_pk_fma_f32 v[228:229], v[228:229], v[160:161], v[160:161] op_sel:[0,1,1]
    v_pk_fma_f32 v[230:231], v[230:231], v[160:161], v[160:161] op_sel:[0,1,1]
    buffer_load_dwordx4 v21, s[24:27], s46 offen offset:3072 lds
    v_rcp_f32 v224, v224
    v_rcp_f32 v225, v225
    v_rcp_f32 v226, v226
    v_rcp_f32 v227, v227
    v_rcp_f32 v228, v228
    v_rcp_f32 v229, v229
    v_rcp_f32 v230, v230
    v_rcp_f32 v231, v231
    s_add_u32 m0, s43, 49152
    s_lshl_b32 s46, s71, 5
    s_nop 0
    buffer_load_dwordx4 v18, s[24:27], s46 offen offset:0 lds
    v_pk_mul_f32 v[32:33], v[32:33], v[224:225]
    v_pk_mul_f32 v[34:35], v[34:35], v[226:227]
    v_pk_mul_f32 v[36:37], v[36:37], v[228:229]
    v_pk_mul_f32 v[38:39], v[38:39], v[230:231]
    v_cvt_pk_bf16_f32 v40, v32, v33
    v_cvt_pk_bf16_f32 v41, v34, v35
    v_cvt_pk_bf16_f32 v42, v36, v37
    v_cvt_pk_bf16_f32 v43, v38, v39
    v_pk_mul_f32 v[232:233], v[48:49], v[166:167] op_sel_hi:[1,0]
    v_pk_mul_f32 v[234:235], v[50:51], v[166:167] op_sel_hi:[1,0]
    v_pk_mul_f32 v[236:237], v[52:53], v[166:167] op_sel_hi:[1,0]
    v_pk_mul_f32 v[238:239], v[54:55], v[166:167] op_sel_hi:[1,0]
    buffer_load_dwordx4 v19, s[24:27], s46 offen offset:1024 lds
    v_exp_f32 v232, v232
    v_exp_f32 v233, v233
    v_exp_f32 v234, v234
    v_exp_f32 v235, v235
    v_exp_f32 v236, v236
    v_exp_f32 v237, v237
    v_exp_f32 v238, v238
    v_exp_f32 v239, v239
    buffer_load_dwordx4 v20, s[24:27], s46 offen offset:2048 lds
    v_pk_mul_f32 v[48:49], v[48:49], v[56:57]
    v_pk_mul_f32 v[50:51], v[50:51], v[58:59]
    v_pk_mul_f32 v[52:53], v[52:53], v[60:61]
    v_pk_mul_f32 v[54:55], v[54:55], v[62:63]
    v_pk_fma_f32 v[232:233], v[232:233], v[164:165], v[164:165] op_sel:[0,1,1]
    v_pk_fma_f32 v[234:235], v[234:235], v[164:165], v[164:165] op_sel:[0,1,1]
    v_pk_fma_f32 v[236:237], v[236:237], v[164:165], v[164:165] op_sel:[0,1,1]
    v_pk_fma_f32 v[238:239], v[238:239], v[164:165], v[164:165] op_sel:[0,1,1]
    buffer_load_dwordx4 v21, s[24:27], s46 offen offset:3072 lds
    v_rcp_f32 v232, v232
    v_rcp_f32 v233, v233
    v_rcp_f32 v234, v234
    v_rcp_f32 v235, v235
    v_rcp_f32 v236, v236
    v_rcp_f32 v237, v237
    v_rcp_f32 v238, v238
    v_rcp_f32 v239, v239
    s_add_u32 m0, s43, 65536
    s_lshl_b32 s46, s72, 5
    s_nop 0
    buffer_load_dwordx4 v18, s[24:27], s46 offen offset:0 lds
    v_pk_mul_f32 v[48:49], v[48:49], v[232:233]
    v_pk_mul_f32 v[50:51], v[50:51], v[234:235]
    v_pk_mul_f32 v[52:53], v[52:53], v[236:237]
    v_pk_mul_f32 v[54:55], v[54:55], v[238:239]
    v_cvt_pk_bf16_f32 v56, v48, v49
    v_cvt_pk_bf16_f32 v57, v50, v51
    v_cvt_pk_bf16_f32 v58, v52, v53
    v_cvt_pk_bf16_f32 v59, v54, v55
    v_fmac_f32_dpp v74, v194, v168 row_newbcast:8 row_mask:0xf bank_mask:0xf
    v_fmac_f32_dpp v75, v195, v168 row_newbcast:8 row_mask:0xf bank_mask:0xf
    v_fmac_f32_dpp v77, v193, v168 row_newbcast:12 row_mask:0xf bank_mask:0xf
    v_fmac_f32_dpp v78, v194, v168 row_newbcast:12 row_mask:0xf bank_mask:0xf
    v_fmac_f32_dpp v79, v195, v168 row_newbcast:12 row_mask:0xf bank_mask:0xf
    v_pk_mul_f32 v[224:225], v[64:65], v[170:171] op_sel_hi:[1,0]
    v_pk_mul_f32 v[226:227], v[66:67], v[170:171] op_sel_hi:[1,0]
    v_pk_mul_f32 v[228:229], v[68:69], v[170:171] op_sel_hi:[1,0]
    v_pk_mul_f32 v[230:231], v[70:71], v[170:171] op_sel_hi:[1,0]
    buffer_load_dwordx4 v19, s[24:27], s46 offen offset:1024 lds
    v_exp_f32 v224, v224
    v_exp_f32 v225, v225
    v_exp_f32 v226, v226
    v_exp_f32 v227, v227
    v_exp_f32 v228, v228
    v_exp_f32 v229, v229
    v_exp_f32 v230, v230
    v_exp_f32 v231, v231
    buffer_load_dwordx4 v20, s[24:27], s46 offen offset:2048 lds
    v_pk_mul_f32 v[64:65], v[64:65], v[72:73]
    v_pk_mul_f32 v[66:67], v[66:67], v[74:75]
    v_pk_mul_f32 v[68:69], v[68:69], v[76:77]
    v_pk_mul_f32 v[70:71], v[70:71], v[78:79]
    v_pk_fma_f32 v[224:225], v[224:225], v[168:169], v[168:169] op_sel:[0,1,1]
    v_pk_fma_f32 v[226:227], v[226:227], v[168:169], v[168:169] op_sel:[0,1,1]
    v_pk_fma_f32 v[228:229], v[228:229], v[168:169], v[168:169] op_sel:[0,1,1]
    v_pk_fma_f32 v[230:231], v[230:231], v[168:169], v[168:169] op_sel:[0,1,1]
    buffer_load_dwordx4 v21, s[24:27], s46 offen offset:3072 lds
    v_rcp_f32 v224, v224
    v_rcp_f32 v225, v225
    v_rcp_f32 v226, v226
    v_rcp_f32 v227, v227
    v_rcp_f32 v228, v228
    v_rcp_f32 v229, v229
    v_rcp_f32 v230, v230
    v_rcp_f32 v231, v231
    v_pk_mul_f32 v[64:65], v[64:65], v[224:225]
    v_pk_mul_f32 v[66:67], v[66:67], v[226:227]
    v_pk_mul_f32 v[68:69], v[68:69], v[228:229]
    v_pk_mul_f32 v[70:71], v[70:71], v[230:231]
    v_cvt_pk_bf16_f32 v72, v64, v65
    v_cvt_pk_bf16_f32 v73, v66, v67
    v_cvt_pk_bf16_f32 v74, v68, v69
    v_cvt_pk_bf16_f32 v75, v70, v71
    buffer_store_dwordx4 v[40:43], v26, s[20:23], s4 offen sc1
    s_add_u32 s4, s4, 57344
    buffer_store_dwordx4 v[56:59], v26, s[20:23], s4 offen sc1
    s_add_u32 s4, s4, 57344
    buffer_store_dwordx4 v[72:75], v26, s[20:23], s4 offen sc1
    s_add_u32 s4, s4, 57344
    v_fmac_f32_dpp v84, v192, v172 row_newbcast:4 row_mask:0xf bank_mask:0xf
    v_fmac_f32_dpp v85, v193, v172 row_newbcast:4 row_mask:0xf bank_mask:0xf
    v_fmac_f32_dpp v86, v194, v172 row_newbcast:4 row_mask:0xf bank_mask:0xf
    v_fmac_f32_dpp v87, v195, v172 row_newbcast:4 row_mask:0xf bank_mask:0xf
    v_fmac_f32_dpp v88, v192, v172 row_newbcast:8 row_mask:0xf bank_mask:0xf
    v_fmac_f32_dpp v89, v193, v172 row_newbcast:8 row_mask:0xf bank_mask:0xf
    v_fmac_f32_dpp v90, v194, v172 row_newbcast:8 row_mask:0xf bank_mask:0xf
    v_fmac_f32_dpp v91, v195, v172 row_newbcast:8 row_mask:0xf bank_mask:0xf
    v_fmac_f32_dpp v92, v192, v172 row_newbcast:12 row_mask:0xf bank_mask:0xf
    v_fmac_f32_dpp v93, v193, v172 row_newbcast:12 row_mask:0xf bank_mask:0xf
    v_fmac_f32_dpp v94, v194, v172 row_newbcast:12 row_mask:0xf bank_mask:0xf
    v_fmac_f32_dpp v95, v195, v172 row_newbcast:12 row_mask:0xf bank_mask:0xf
    v_pk_mul_f32 v[232:233], v[80:81], v[174:175] op_sel_hi:[1,0]
    v_pk_mul_f32 v[234:235], v[82:83], v[174:175] op_sel_hi:[1,0]
    v_pk_mul_f32 v[236:237], v[84:85], v[174:175] op_sel_hi:[1,0]
    v_pk_mul_f32 v[238:239], v[86:87], v[174:175] op_sel_hi:[1,0]
    v_exp_f32 v232, v232
    v_exp_f32 v233, v233
    v_exp_f32 v234, v234
    v_exp_f32 v235, v235
    v_exp_f32 v236, v236
    v_exp_f32 v237, v237
    v_exp_f32 v238, v238
    v_exp_f32 v239, v239
    v_pk_mul_f32 v[80:81], v[80:81], v[88:89]
    v_pk_mul_f32 v[82:83], v[82:83], v[90:91]
    v_pk_mul_f32 v[84:85], v[84:85], v[92:93]
    v_pk_mul_f32 v[86:87], v[86:87], v[94:95]
    v_pk_fma_f32 v[232:233], v[232:233], v[172:173], v[172:173] op_sel:[0,1,1]
    v_pk_fma_f32 v[234:235], v[234:235], v[172:173], v[172:173] op_sel:[0,1,1]
    v_pk_fma_f32 v[236:237], v[236:237], v[172:173], v[172:173] op_sel:[0,1,1]
    v_pk_fma_f32 v[238:239], v[238:239], v[172:173], v[172:173] op_sel:[0,1,1]
    v_rcp_f32 v232, v232
    v_rcp_f32 v233, v233
    v_rcp_f32 v234, v234
    v_rcp_f32 v235, v235
    v_rcp_f32 v236, v236
    v_rcp_f32 v237, v237
    v_rcp_f32 v238, v238
    v_rcp_f32 v239, v239
    v_pk_mul_f32 v[80:81], v[80:81], v[232:233]
    v_pk_mul_f32 v[82:83], v[82:83], v[234:235]
    v_pk_mul_f32 v[84:85], v[84:85], v[236:237]
    v_pk_mul_f32 v[86:87], v[86:87], v[238:239]
    v_cvt_pk_bf16_f32 v88, v80, v81
    v_cvt_pk_bf16_f32 v89, v82, v83
    v_cvt_pk_bf16_f32 v90, v84, v85
    v_cvt_pk_bf16_f32 v91, v86, v87
    buffer_store_dwordx4 v[88:91], v26, s[20:23], s4 offen sc1
    s_add_u32 s4, s4, 57344
    v_mfma_f32_16x16x32_bf16 v[96:99], a[144:147], a[64:67], v[96:99]
    ds_read_b128 a[112:115], v16 offset:18432
    s_waitcnt lgkmcnt(3)
    s_nop 0
    v_mfma_f32_16x16x32_bf16 v[96:99], a[176:179], a[68:71], v[96:99]
    ds_read_b128 a[116:119], v17 offset:18432
    v_fmac_f32_dpp v108, v192, v176 row_newbcast:12 row_mask:0xf bank_mask:0xf
    v_mfma_f32_16x16x32_bf16 v[100:103], a[180:183], a[68:71], v[100:103]
    ds_read_b64_tr_b16 a[36:37], v23 offset:0
    v_fmac_f32_dpp v109, v193, v176 row_newbcast:12 row_mask:0xf bank_mask:0xf
    v_mfma_f32_16x16x32_bf16 v[100:103], a[148:151], a[64:67], v[100:103]
    ds_read_b128 a[120:123], v16 offset:26624
    v_fmac_f32_dpp v112, v192, v180 row_newbcast:0 row_mask:0xf bank_mask:0xf
    v_mfma_f32_16x16x32_bf16 v[104:107], a[152:155], a[64:67], v[104:107]
    ds_read_b128 a[124:127], v17 offset:26624
    v_fmac_f32_dpp v113, v193, v180 row_newbcast:0 row_mask:0xf bank_mask:0xf
    v_mfma_f32_16x16x32_bf16 v[104:107], a[184:187], a[68:71], v[104:107]
    ds_read_b128 a[128:131], v16 offset:19456
    v_fmac_f32_dpp v114, v194, v180 row_newbcast:0 row_mask:0xf bank_mask:0xf
    v_mfma_f32_16x16x32_bf16 v[108:111], a[188:191], a[68:71], v[108:111]
    ds_read_b64_tr_b16 a[38:39], v23 offset:2048
    v_fmac_f32_dpp v115, v195, v180 row_newbcast:0 row_mask:0xf bank_mask:0xf
    v_mfma_f32_16x16x32_bf16 v[108:111], a[156:159], a[64:67], v[108:111]
    ds_read_b128 a[132:135], v17 offset:19456
    v_fmac_f32_dpp v116, v192, v180 row_newbcast:4 row_mask:0xf bank_mask:0xf
    v_mfma_f32_16x16x32_bf16 v[124:127], a[156:159], a[72:75], v[124:127]
    ds_read_b128 a[136:139], v16 offset:27648
    v_fmac_f32_dpp v117, v193, v180 row_newbcast:4 row_mask:0xf bank_mask:0xf
    v_mfma_f32_16x16x32_bf16 v[124:127], a[188:191], a[76:79], v[124:127]
    ds_read_b128 a[140:143], v17 offset:27648
    v_fmac_f32_dpp v128, v192, v184 row_newbcast:0 row_mask:0xf bank_mask:0xf
    v_mfma_f32_16x16x32_bf16 v[120:123], a[184:187], a[76:79], v[120:123]
    ds_read_b64_tr_b16 a[40:41], v24 offset:0
    v_fmac_f32_dpp v129, v193, v184 row_newbcast:0 row_mask:0xf bank_mask:0xf
    v_mfma_f32_16x16x32_bf16 v[120:123], a[152:155], a[72:75], v[120:123]
    ds_read_b64_tr_b16 a[42:43], v24 offset:2048
    v_fmac_f32_dpp v100, v192, v176 row_newbcast:4 row_mask:0xf bank_mask:0xf
    v_mfma_f32_16x16x32_bf16 v[116:119], a[148:151], a[72:75], v[116:119]
    ds_read_b64_tr_b16 a[44:45], v25 offset:0
    v_fmac_f32_dpp v101, v193, v176 row_newbcast:4 row_mask:0xf bank_mask:0xf
    v_mfma_f32_16x16x32_bf16 v[116:119], a[180:183], a[76:79], v[116:119]
    ds_read_b64_tr_b16 a[46:47], v25 offset:2048
    v_fmac_f32_dpp v102, v194, v176 row_newbcast:4 row_mask:0xf bank_mask:0xf
    v_mfma_f32_16x16x32_bf16 v[112:115], a[176:179], a[76:79], v[112:115]
    s_waitcnt vmcnt(20)
    v_fmac_f32_dpp v103, v195, v176 row_newbcast:4 row_mask:0xf bank_mask:0xf
    v_fmac_f32_dpp v104, v192, v176 row_newbcast:8 row_mask:0xf bank_mask:0xf
    v_mfma_f32_16x16x32_bf16 v[112:115], a[144:147], a[72:75], v[112:115]
    v_fmac_f32_dpp v105, v193, v176 row_newbcast:8 row_mask:0xf bank_mask:0xf
    v_fmac_f32_dpp v106, v194, v176 row_newbcast:8 row_mask:0xf bank_mask:0xf
    v_mfma_f32_16x16x32_bf16 v[128:131], a[144:147], a[80:83], v[128:131]
    s_add_u32 m0, s43, 114688
    v_fmac_f32_dpp v107, v195, v176 row_newbcast:8 row_mask:0xf bank_mask:0xf
    v_fmac_f32_dpp v110, v194, v176 row_newbcast:12 row_mask:0xf bank_mask:0xf
    v_mfma_f32_16x16x32_bf16 v[128:131], a[176:179], a[84:87], v[128:131]
    s_lshl_b32 s46, s73, 5
    v_fmac_f32_dpp v111, v195, v176 row_newbcast:12 row_mask:0xf bank_mask:0xf
    v_fmac_f32_dpp v124, v192, v180 row_newbcast:12 row_mask:0xf bank_mask:0xf
    v_mfma_f32_16x16x32_bf16 v[132:135], a[180:183], a[84:87], v[132:135]
    buffer_load_dwordx4 v18, s[24:27], s46 offen offset:0 lds
    v_mfma_f32_16x16x32_bf16 v[132:135], a[148:151], a[80:83], v[132:135]
    v_fmac_f32_dpp v120, v192, v180 row_newbcast:8 row_mask:0xf bank_mask:0xf
    v_fmac_f32_dpp v121, v193, v180 row_newbcast:8 row_mask:0xf bank_mask:0xf
    v_mfma_f32_16x16x32_bf16 v[136:139], a[152:155], a[80:83], v[136:139]
    v_fmac_f32_dpp v122, v194, v180 row_newbcast:8 row_mask:0xf bank_mask:0xf
    v_fmac_f32_dpp v123, v195, v180 row_newbcast:8 row_mask:0xf bank_mask:0xf
    v_mfma_f32_16x16x32_bf16 v[136:139], a[184:187], a[84:87], v[136:139]
    v_fmac_f32_dpp v118, v194, v180 row_newbcast:4 row_mask:0xf bank_mask:0xf
    v_fmac_f32_dpp v119, v195, v180 row_newbcast:4 row_mask:0xf bank_mask:0xf
    v_mfma_f32_16x16x32_bf16 v[140:143], a[188:191], a[84:87], v[140:143]
    buffer_load_dwordx4 v19, s[24:27], s46 offen offset:1024 lds
    v_mfma_f32_16x16x32_bf16 v[140:143], a[156:159], a[80:83], v[140:143]
    v_fmac_f32_dpp v125, v193, v180 row_newbcast:12 row_mask:0xf bank_mask:0xf
    v_fmac_f32_dpp v126, v194, v180 row_newbcast:12 row_mask:0xf bank_mask:0xf
    v_mfma_f32_16x16x32_bf16 v[156:159], a[156:159], a[88:91], v[156:159]
    v_fmac_f32_dpp v127, v195, v180 row_newbcast:12 row_mask:0xf bank_mask:0xf
    v_fmac_f32_dpp v144, v192, v188 row_newbcast:0 row_mask:0xf bank_mask:0xf
    v_mfma_f32_16x16x32_bf16 v[156:159], a[188:191], a[92:95], v[156:159]
    v_fmac_f32_dpp v130, v194, v184 row_newbcast:0 row_mask:0xf bank_mask:0xf
    v_fmac_f32_dpp v131, v195, v184 row_newbcast:0 row_mask:0xf bank_mask:0xf
    v_mfma_f32_16x16x32_bf16 v[152:155], a[184:187], a[92:95], v[152:155]
    buffer_load_dwordx4 v20, s[24:27], s46 offen offset:2048 lds
    v_mfma_f32_16x16x32_bf16 v[152:155], a[152:155], a[88:91], v[152:155]
    v_fmac_f32_dpp v132, v192, v184 row_newbcast:4 row_mask:0xf bank_mask:0xf
    v_fmac_f32_dpp v133, v193, v184 row_newbcast:4 row_mask:0xf bank_mask:0xf
    v_mfma_f32_16x16x32_bf16 v[148:151], a[148:151], a[88:91], v[148:151]
    v_fmac_f32_dpp v134, v194, v184 row_newbcast:4 row_mask:0xf bank_mask:0xf
    v_fmac_f32_dpp v135, v195, v184 row_newbcast:4 row_mask:0xf bank_mask:0xf
    v_mfma_f32_16x16x32_bf16 v[148:151], a[180:183], a[92:95], v[148:151]
    v_fmac_f32_dpp v136, v192, v184 row_newbcast:8 row_mask:0xf bank_mask:0xf
    v_fmac_f32_dpp v137, v193, v184 row_newbcast:8 row_mask:0xf bank_mask:0xf
    v_mfma_f32_16x16x32_bf16 v[144:147], a[176:179], a[92:95], v[144:147]
    buffer_load_dwordx4 v21, s[24:27], s46 offen offset:3072 lds
    v_mfma_f32_16x16x32_bf16 v[144:147], a[144:147], a[88:91], v[144:147]
    s_waitcnt lgkmcnt(4)
    s_barrier
    v_mfma_f32_16x16x32_bf16 v[96:99], a[96:99], a[112:115], v[96:99]
    s_add_u32 m0, s43, 131072
    v_fmac_f32_dpp v138, v194, v184 row_newbcast:8 row_mask:0xf bank_mask:0xf
    v_fmac_f32_dpp v139, v195, v184 row_newbcast:8 row_mask:0xf bank_mask:0xf
    v_mfma_f32_16x16x32_bf16 v[96:99], a[160:163], a[116:119], v[96:99]
    s_lshl_b32 s46, s74, 261
    v_fmac_f32_dpp v140, v192, v184 row_newbcast:12 row_mask:0xf bank_mask:0xf
    v_fmac_f32_dpp v141, v193, v184 row_newbcast:12 row_mask:0xf bank_mask:0xf
    v_mfma_f32_16x16x32_bf16 v[100:103], a[164:167], a[116:119], v[100:103]
    buffer_load_dwordx4 v18, s[24:27], s46 offen offset:0 lds
    v_mfma_f32_16x16x32_bf16 v[100:103], a[100:103], a[112:115], v[100:103]
    v_fmac_f32_dpp v142, v194, v184 row_newbcast:12 row_mask:0xf bank_mask:0xf
    v_fmac_f32_dpp v143, v195, v184 row_newbcast:12 row_mask:0xf bank_mask:0xf
    v_mfma_f32_16x16x32_bf16 v[104:107], a[104:107], a[112:115], v[104:107]
    v_fmac_f32_dpp v152, v192, v188 row_newbcast:8 row_mask:0xf bank_mask:0xf
    v_fmac_f32_dpp v153, v193, v188 row_newbcast:8 row_mask:0xf bank_mask:0xf
    v_mfma_f32_16x16x32_bf16 v[104:107], a[168:171], a[116:119], v[104:107]
    v_fmac_f32_dpp v148, v192, v188 row_newbcast:4 row_mask:0xf bank_mask:0xf
    v_fmac_f32_dpp v149, v193, v188 row_newbcast:4 row_mask:0xf bank_mask:0xf
    v_mfma_f32_16x16x32_bf16 v[108:111], a[172:175], a[116:119], v[108:111]
    buffer_load_dwordx4 v19, s[24:27], s46 offen offset:1024 lds
    v_mfma_f32_16x16x32_bf16 v[108:111], a[108:111], a[112:115], v[108:111]
    v_fmac_f32_dpp v145, v193, v188 row_newbcast:0 row_mask:0xf bank_mask:0xf
    v_fmac_f32_dpp v146, v194, v188 row_newbcast:0 row_mask:0xf bank_mask:0xf
    v_mfma_f32_16x16x32_bf16 v[124:127], a[108:111], a[120:123], v[124:127]
    v_fmac_f32_dpp v147, v195, v188 row_newbcast:0 row_mask:0xf bank_mask:0xf
    v_fmac_f32_dpp v150, v194, v188 row_newbcast:4 row_mask:0xf bank_mask:0xf
    v_mfma_f32_16x16x32_bf16 v[124:127], a[172:175], a[124:127], v[124:127]
    v_fmac_f32_dpp v151, v195, v188 row_newbcast:4 row_mask:0xf bank_mask:0xf
    v_fmac_f32_dpp v154, v194, v188 row_newbcast:8 row_mask:0xf bank_mask:0xf
    v_mfma_f32_16x16x32_bf16 v[120:123], a[168:171], a[124:127], v[120:123]
    buffer_load_dwordx4 v20, s[24:27], s46 offen offset:2048 lds
    v_mfma_f32_16x16x32_bf16 v[120:123], a[104:107], a[120:123], v[120:123]
    v_fmac_f32_dpp v155, v195, v188 row_newbcast:8 row_mask:0xf bank_mask:0xf
    v_fmac_f32_dpp v156, v192, v188 row_newbcast:12 row_mask:0xf bank_mask:0xf
    v_mfma_f32_16x16x32_bf16 v[116:119], a[100:103], a[120:123], v[116:119]
    v_fmac_f32_dpp v157, v193, v188 row_newbcast:12 row_mask:0xf bank_mask:0xf
    v_fmac_f32_dpp v158, v194, v188 row_newbcast:12 row_mask:0xf bank_mask:0xf
    v_mfma_f32_16x16x32_bf16 v[116:119], a[164:167], a[124:127], v[116:119]
    ds_read_b64_tr_b16 a[192:193], v204 offset:0
    v_fmac_f32_dpp v159, v195, v188 row_newbcast:12 row_mask:0xf bank_mask:0xf
    v_mfma_f32_16x16x32_bf16 v[112:115], a[160:163], a[124:127], v[112:115]
    buffer_load_dwordx4 v21, s[24:27], s46 offen offset:3072 lds
    v_mfma_f32_16x16x32_bf16 v[112:115], a[96:99], a[120:123], v[112:115]
    ds_read_b64_tr_b16 a[194:195], v204 offset:2048
    v_mfma_f32_16x16x32_bf16 v[128:131], a[96:99], a[128:131], v[128:131]
    ds_read_b64_tr_b16 a[196:197], v205 offset:0
    s_add_u32 m0, s43, 81920
    v_mfma_f32_16x16x32_bf16 v[128:131], a[160:163], a[132:135], v[128:131]
    ds_read_b64_tr_b16 a[198:199], v205 offset:2048
    s_lshl_b32 s46, s75, 261
    v_mfma_f32_16x16x32_bf16 v[132:135], a[164:167], a[132:135], v[132:135]
    buffer_load_dwordx4 v18, s[24:27], s46 offen offset:0 lds
    v_mfma_f32_16x16x32_bf16 v[132:135], a[100:103], a[128:131], v[132:135]
    ds_read_b64_tr_b16 a[200:201], v206 offset:0
    v_mfma_f32_16x16x32_bf16 v[136:139], a[104:107], a[128:131], v[136:139]
    ds_read_b64_tr_b16 a[202:203], v206 offset:2048
    v_mfma_f32_16x16x32_bf16 v[136:139], a[168:171], a[132:135], v[136:139]
    ds_read_b64_tr_b16 a[204:205], v207 offset:0
    v_mfma_f32_16x16x32_bf16 v[140:143], a[172:175], a[132:135], v[140:143]
    buffer_load_dwordx4 v19, s[24:27], s46 offen offset:1024 lds
    v_mfma_f32_16x16x32_bf16 v[140:143], a[108:111], a[128:131], v[140:143]
    ds_read_b64_tr_b16 a[206:207], v207 offset:2048
    v_mfma_f32_16x16x32_bf16 v[156:159], a[108:111], a[136:139], v[156:159]
    v_mfma_f32_16x16x32_bf16 v[156:159], a[172:175], a[140:143], v[156:159]
    v_mfma_f32_16x16x32_bf16 v[152:155], a[168:171], a[140:143], v[152:155]
    buffer_load_dwordx4 v20, s[24:27], s46 offen offset:2048 lds
    v_mfma_f32_16x16x32_bf16 v[152:155], a[104:107], a[136:139], v[152:155]
    v_mfma_f32_16x16x32_bf16 v[148:151], a[100:103], a[136:139], v[148:151]
    v_mfma_f32_16x16x32_bf16 v[148:151], a[164:167], a[140:143], v[148:151]
    v_mfma_f32_16x16x32_bf16 v[144:147], a[160:163], a[140:143], v[144:147]
    buffer_load_dwordx4 v21, s[24:27], s46 offen offset:3072 lds
    v_mfma_f32_16x16x32_bf16 v[144:147], a[96:99], a[136:139], v[144:147]
k_fepi:
    s_waitcnt lgkmcnt(0)
    s_waitcnt vmcnt(20)
    .p2align 3
    v_pk_mul_f32 v[224:225], v[96:97], v[178:179] op_sel_hi:[1,0]
    v_pk_mul_f32 v[226:227], v[98:99], v[178:179] op_sel_hi:[1,0]
    v_pk_mul_f32 v[228:229], v[100:101], v[178:179] op_sel_hi:[1,0]
    v_pk_mul_f32 v[230:231], v[102:103], v[178:179] op_sel_hi:[1,0]
    s_add_u32 m0, s43, 98304
    s_lshl_b32 s46, s76, 5
    s_nop 0
    buffer_load_dwordx4 v18, s[24:27], s46 offen offset:0 lds
    v_exp_f32 v224, v224
    v_exp_f32 v225, v225
    v_exp_f32 v226, v226
    v_exp_f32 v227, v227
    v_exp_f32 v228, v228
    v_exp_f32 v229, v229
    v_exp_f32 v230, v230
    v_exp_f32 v231, v231
    buffer_load_dwordx4 v19, s[24:27], s46 offen offset:1024 lds
    v_pk_mul_f32 v[96:97], v[96:97], v[104:105]
    v_pk_mul_f32 v[98:99], v[98:99], v[106:107]
    v_pk_mul_f32 v[100:101], v[100:101], v[108:109]
    v_pk_mul_f32 v[102:103], v[102:103], v[110:111]
    v_pk_fma_f32 v[224:225], v[224:225], v[176:177], v[176:177] op_sel:[0,1,1]
    v_pk_fma_f32 v[226:227], v[226:227], v[176:177], v[176:177] op_sel:[0,1,1]
    v_pk_fma_f32 v[228:229], v[228:229], v[176:177], v[176:177] op_sel:[0,1,1]
    v_pk_fma_f32 v[230:231], v[230:231], v[176:177], v[176:177] op_sel:[0,1,1]
    buffer_load_dwordx4 v20, s[24:27], s46 offen offset:2048 lds
    v_rcp_f32 v224, v224
    v_rcp_f32 v225, v225
    v_rcp_f32 v226, v226
    v_rcp_f32 v227, v227
    v_rcp_f32 v228, v228
    v_rcp_f32 v229, v229
    v_rcp_f32 v230, v230
    v_rcp_f32 v231, v231
    buffer_load_dwordx4 v21, s[24:27], s46 offen offset:3072 lds
    v_pk_mul_f32 v[96:97], v[96:97], v[224:225]
    v_pk_mul_f32 v[98:99], v[98:99], v[226:227]
    v_pk_mul_f32 v[100:101], v[100:101], v[228:229]
    v_pk_mul_f32 v[102:103], v[102:103], v[230:231]
    v_cvt_pk_bf16_f32 v104, v96, v97
    v_cvt_pk_bf16_f32 v105, v98, v99
    v_cvt_pk_bf16_f32 v106, v100, v101
    v_cvt_pk_bf16_f32 v107, v102, v103
    buffer_store_dwordx4 v[104:107], v26, s[20:23], s4 offen sc1
    s_add_u32 s4, s4, 57344
    s_waitcnt vmcnt(17)
    s_barrier
    s_mov_b32 s97, 1
    s_cmp_lg_u32 s60, 0
    s_atomic_add s97, s[20:21], s47 offset:0
    s_cbranch_scc1 k_nf1
    s_atomic_add s97, s[20:21], s47 offset:512
k_nf1:
    s_nop 0
    v_pk_mul_f32 v[232:233], v[112:113], v[182:183] op_sel_hi:[1,0]
    v_pk_mul_f32 v[234:235], v[114:115], v[182:183] op_sel_hi:[1,0]
    v_pk_mul_f32 v[236:237], v[116:117], v[182:183] op_sel_hi:[1,0]
    v_pk_mul_f32 v[238:239], v[118:119], v[182:183] op_sel_hi:[1,0]
    v_exp_f32 v232, v232
    v_exp_f32 v233, v233
    v_exp_f32 v234, v234
    v_exp_f32 v235, v235
    v_exp_f32 v236, v236
    v_exp_f32 v237, v237
    v_exp_f32 v238, v238
    v_exp_f32 v239, v239
    v_pk_mul_f32 v[112:113], v[112:113], v[120:121]
    v_pk_mul_f32 v[114:115], v[114:115], v[122:123]
    v_pk_mul_f32 v[116:117], v[116:117], v[124:125]
    v_pk_mul_f32 v[118:119], v[118:119], v[126:127]
    v_pk_fma_f32 v[232:233], v[232:233], v[180:181], v[180:181] op_sel:[0,1,1]
    v_pk_fma_f32 v[234:235], v[234:235], v[180:181], v[180:181] op_sel:[0,1,1]
    v_pk_fma_f32 v[236:237], v[236:237], v[180:181], v[180:181] op_sel:[0,1,1]
    v_pk_fma_f32 v[238:239], v[238:239], v[180:181], v[180:181] op_sel:[0,1,1]
    v_rcp_f32 v232, v232
    v_rcp_f32 v233, v233
    v_rcp_f32 v234, v234
    v_rcp_f32 v235, v235
    v_rcp_f32 v236, v236
    v_rcp_f32 v237, v237
    v_rcp_f32 v238, v238
    v_rcp_f32 v239, v239
    v_pk_mul_f32 v[112:113], v[112:113], v[232:233]
    v_pk_mul_f32 v[114:115], v[114:115], v[234:235]
    v_pk_mul_f32 v[116:117], v[116:117], v[236:237]
    v_pk_mul_f32 v[118:119], v[118:119], v[238:239]
    v_cvt_pk_bf16_f32 v120, v112, v113
    v_cvt_pk_bf16_f32 v121, v114, v115
    v_cvt_pk_bf16_f32 v122, v116, v117
    v_cvt_pk_bf16_f32 v123, v118, v119
    buffer_store_dwordx4 v[120:123], v26, s[20:23], s4 offen sc1
    s_add_u32 s4, s4, 57344
    v_pk_mul_f32 v[224:225], v[128:129], v[186:187] op_sel_hi:[1,0]
    v_pk_mul_f32 v[226:227], v[130:131], v[186:187] op_sel_hi:[1,0]
    v_pk_mul_f32 v[228:229], v[132:133], v[186:187] op_sel_hi:[1,0]
    v_pk_mul_f32 v[230:231], v[134:135], v[186:187] op_sel_hi:[1,0]
    v_exp_f32 v224, v224
    v_exp_f32 v225, v225
    v_exp_f32 v226, v226
    v_exp_f32 v227, v227
    v_exp_f32 v228, v228
    v_exp_f32 v229, v229
    v_exp_f32 v230, v230
    v_exp_f32 v231, v231
    v_pk_mul_f32 v[128:129], v[128:129], v[136:137]
    v_pk_mul_f32 v[130:131], v[130:131], v[138:139]
    v_pk_mul_f32 v[132:133], v[132:133], v[140:141]
    v_pk_mul_f32 v[134:135], v[134:135], v[142:143]
    v_pk_fma_f32 v[224:225], v[224:225], v[184:185], v[184:185] op_sel:[0,1,1]
    v_pk_fma_f32 v[226:227], v[226:227], v[184:185], v[184:185] op_sel:[0,1,1]
    v_pk_fma_f32 v[228:229], v[228:229], v[184:185], v[184:185] op_sel:[0,1,1]
    v_pk_fma_f32 v[230:231], v[230:231], v[184:185], v[184:185] op_sel:[0,1,1]
    v_rcp_f32 v224, v224
    v_rcp_f32 v225, v225
    v_rcp_f32 v226, v226
    v_rcp_f32 v227, v227
    v_rcp_f32 v228, v228
    v_rcp_f32 v229, v229
    v_rcp_f32 v230, v230
    v_rcp_f32 v231, v231
    v_pk_mul_f32 v[128:129], v[128:129], v[224:225]
    v_pk_mul_f32 v[130:131], v[130:131], v[226:227]
    v_pk_mul_f32 v[132:133], v[132:133], v[228:229]
    v_pk_mul_f32 v[134:135], v[134:135], v[230:231]
    v_cvt_pk_bf16_f32 v136, v128, v129
    v_cvt_pk_bf16_f32 v137, v130, v131
    v_cvt_pk_bf16_f32 v138, v132, v133
    v_cvt_pk_bf16_f32 v139, v134, v135
    buffer_store_dwordx4 v[136:139], v26, s[20:23], s4 offen sc1
    s_add_u32 s4, s4, 57344
    v_pk_mul_f32 v[232:233], v[144:145], v[190:191] op_sel_hi:[1,0]
    v_pk_mul_f32 v[234:235], v[146:147], v[190:191] op_sel_hi:[1,0]
    v_pk_mul_f32 v[236:237], v[148:149], v[190:191] op_sel_hi:[1,0]
    v_pk_mul_f32 v[238:239], v[150:151], v[190:191] op_sel_hi:[1,0]
    v_exp_f32 v232, v232
    v_exp_f32 v233, v233
    v_exp_f32 v234, v234
    v_exp_f32 v235, v235
    v_exp_f32 v236, v236
    v_exp_f32 v237, v237
    v_exp_f32 v238, v238
    v_exp_f32 v239, v239
    v_pk_mul_f32 v[144:145], v[144:145], v[152:153]
    v_pk_mul_f32 v[146:147], v[146:147], v[154:155]
    v_pk_mul_f32 v[148:149], v[148:149], v[156:157]
    v_pk_mul_f32 v[150:151], v[150:151], v[158:159]
    v_pk_fma_f32 v[232:233], v[232:233], v[188:189], v[188:189] op_sel:[0,1,1]
    v_pk_fma_f32 v[234:235], v[234:235], v[188:189], v[188:189] op_sel:[0,1,1]
    v_pk_fma_f32 v[236:237], v[236:237], v[188:189], v[188:189] op_sel:[0,1,1]
    v_pk_fma_f32 v[238:239], v[238:239], v[188:189], v[188:189] op_sel:[0,1,1]
    v_rcp_f32 v232, v232
    v_rcp_f32 v233, v233
    v_rcp_f32 v234, v234
    v_rcp_f32 v235, v235
    v_rcp_f32 v236, v236
    v_rcp_f32 v237, v237
    v_rcp_f32 v238, v238
    v_rcp_f32 v239, v239
    v_pk_mul_f32 v[144:145], v[144:145], v[232:233]
    v_pk_mul_f32 v[146:147], v[146:147], v[234:235]
    v_pk_mul_f32 v[148:149], v[148:149], v[236:237]
    v_pk_mul_f32 v[150:151], v[150:151], v[238:239]
    v_cvt_pk_bf16_f32 v152, v144, v145
    v_cvt_pk_bf16_f32 v153, v146, v147
    v_cvt_pk_bf16_f32 v154, v148, v149
    v_cvt_pk_bf16_f32 v155, v150, v151
    buffer_store_dwordx4 v[152:155], v26, s[20:23], s4 offen sc1
    s_add_u32 s47, s47, 2048
    s_load_dword s96, s[20:21], s58 glc
    buffer_load_dwordx4 v[196:199], v12, s[8:11], s48 offen
    ds_read_b64_tr_b16 a[48:49], v22 offset:49152
    ds_read_b64_tr_b16 a[50:51], v22 offset:51200
    ds_read_b64_tr_b16 a[52:53], v23 offset:49152
    ds_read_b64_tr_b16 a[54:55], v23 offset:51200
k_padB:
    s_mov_b64 vcc, 0
    s_mov_b64 exec, 0
    s_cmp_eq_u32 s38, 0
    s_cbranch_scc1 k_pad7
    s_cmp_eq_u32 s38, 1
    s_cbranch_scc1 k_pad8
    s_cmp_eq_u32 s38, 2
    s_cbranch_scc1 k_pad2
    s_branch k_padbackB
k_padbackB:
    s_mov_b64 exec, -1
    buffer_load_dwordx4 v[200:203], v12, s[8:11], s39 offen
    ds_read_b64_tr_b16 a[56:57], v24 offset:49152
    ds_read_b64_tr_b16 a[58:59], v24 offset:51200
    ds_read_b64_tr_b16 a[60:61], v25 offset:49152
    ds_read_b64_tr_b16 a[62:63], v25 offset:51200
    ds_read_b64_tr_b16 a[208:209], v204 offset:16384
    ds_read_b64_tr_b16 a[210:211], v204 offset:18432
    ds_read_b64_tr_b16 a[212:213], v205 offset:16384
    s_add_u32 m0, s43, 147456
    s_lshl_b32 s46, s77, 5
    s_waitcnt lgkmcnt(3)
    buffer_load_dwordx4 v18, s[24:27], s46 offen offset:0 lds
    buffer_load_dwordx4 v19, s[24:27], s46 offen offset:1024 lds
    ds_read_b64_tr_b16 a[214:215], v205 offset:18432
    ds_read_b64_tr_b16 a[216:217], v206 offset:16384
    ds_read_b64_tr_b16 a[218:219], v206 offset:18432
    ds_read_b64_tr_b16 a[220:221], v207 offset:16384
    ds_read_b64_tr_b16 a[222:223], v207 offset:18432
    ds_read_b64_tr_b16 a[224:225], v204 offset:32768
    ds_read_b64_tr_b16 a[226:227], v204 offset:34816
    ds_read_b64_tr_b16 a[228:229], v205 offset:32768
    ds_read_b64_tr_b16 a[230:231], v205 offset:34816
    ds_read_b64_tr_b16 a[232:233], v206 offset:32768
    ds_read_b64_tr_b16 a[234:235], v206 offset:34816
    buffer_load_dwordx4 v20, s[24:27], s46 offen offset:2048 lds
    ds_read_b64_tr_b16 a[236:237], v207 offset:32768
    ds_read_b64_tr_b16 a[238:239], v207 offset:34816
    ds_read_b64_tr_b16 a[240:241], v204 offset:49152
    ds_read_b64_tr_b16 a[242:243], v204 offset:51200
    ds_read_b64_tr_b16 a[244:245], v205 offset:49152
    ds_read_b64_tr_b16 a[246:247], v205 offset:51200
    ds_read_b64_tr_b16 a[248:249], v206 offset:49152
    ds_read_b64_tr_b16 a[250:251], v206 offset:51200
    ds_read_b64_tr_b16 a[252:253], v207 offset:49152
    ds_read_b64_tr_b16 a[254:255], v207 offset:51200
    buffer_load_dwordx4 v21, s[24:27], s46 offen offset:3072 lds
    s_waitcnt lgkmcnt(0)
    s_cmp_lt_i32 s96, 3
    s_cbranch_scc0 fl0_back
fl0_spin:
    s_add_u32 s63, s63, 1
    s_cmp_gt_u32 s63, 0x40000
    s_cbranch_scc1 fl0_back
    s_load_dword s96, s[20:21], s58 glc
    s_waitcnt lgkmcnt(0)
    s_cmp_lt_i32 s96, 3
    s_cbranch_scc1 fl0_spin
fl0_back:
    buffer_load_dwordx4 v[112:115], v9, s[20:23], s64 offen sc1
k_pad7:
    s_cbranch_execz k_padret
    s_nop 0
    buffer_load_dwordx4 v[116:119], v9, s[20:23], s65 offen sc1
    buffer_load_dwordx4 v[120:123], v8, s[20:23], s64 offen sc1
    buffer_load_dwordx4 v[124:127], v8, s[20:23], s65 offen sc1
    s_waitcnt vmcnt(10)
    s_barrier
    s_mov_b32 s97, 1
    s_cmp_lg_u32 s60, 0
    s_atomic_add s97, s[20:21], s47 offset:0
    s_cbranch_scc1 k_nf2
    s_atomic_add s97, s[20:21], s47 offset:512
k_nf2:
    buffer_load_dwordx4 v[128:131], v9, s[20:23], s66 offen sc1
    buffer_load_dwordx4 v[132:135], v9, s[20:23], s67 offen sc1
    buffer_load_dwordx4 v[136:139], v8, s[20:23], s66 offen sc1
    buffer_load_dwordx4 v[140:143], v8, s[20:23], s67 offen sc1
    buffer_load_dwordx4 v[144:147], v9, s[20:23], s68 offen sc1
    buffer_load_dwordx4 v[148:151], v9, s[20:23], s69 offen sc1
    buffer_load_dwordx4 v[152:155], v8, s[20:23], s68 offen sc1
    buffer_load_dwordx4 v[156:159], v8, s[20:23], s69 offen sc1
k_p2:
k_pad0:
    s_cbranch_execz k_padbackD
    s_nop 0
    s_waitcnt vmcnt(10)
    v_mfma_f32_16x16x32_bf16 v[56:59], a[8:11], v[112:115], 0
    ds_read_b64_tr_b16 a[64:65], v220 offset:0
    v_lshl_add_u32 v18, v1, 12, v26
    v_mfma_f32_16x16x32_bf16 v[56:59], a[24:27], v[116:119], v[56:59]
    buffer_load_dwordx4 v[160:163], v9, s[20:23], s70 offen sc1
    v_mfma_f32_16x16x32_bf16 v[60:63], a[12:15], v[112:115], 0
    ds_read_b64_tr_b16 a[66:67], v220 offset:2048
    v_xor_b32 v19, 4096, v18
    v_mfma_f32_16x16x32_bf16 v[60:63], a[28:31], v[116:119], v[60:63]
    ds_read_b64_tr_b16 a[68:69], v221 offset:0
    v_xor_b32 v20, 8192, v18
    v_mfma_f32_16x16x32_bf16 v[48:51], a[0:3], v[112:115], 0
    ds_read_b64_tr_b16 a[70:71], v221 offset:2048
    v_xor_b32 v21, 12288, v18
    v_mfma_f32_16x16x32_bf16 v[48:51], a[16:19], v[116:119], v[48:51]
    buffer_load_dwordx4 v[164:167], v9, s[20:23], s71 offen sc1
    v_mfma_f32_16x16x32_bf16 v[52:55], a[4:7], v[112:115], 0
    ds_read_b64_tr_b16 a[72:73], v222 offset:0
    s_lshr_b32 s51, s50, 258
    v_mfma_f32_16x16x32_bf16 v[52:55], a[20:23], v[116:119], v[52:55]
    ds_read_b64_tr_b16 a[74:75], v222 offset:2048
    s_waitcnt vmcnt(10)
    v_mfma_f32_16x16x32_bf16 v[40:43], a[8:11], v[120:123], 0
    ds_read_b64_tr_b16 a[76:77], v223 offset:0
    s_min_u32 s52, s49, 1
    v_mfma_f32_16x16x32_bf16 v[40:43], a[24:27], v[124:127], v[40:43]
    buffer_load_dwordx4 v[112:115], v8, s[20:23], s70 offen sc1
    v_mfma_f32_16x16x32_bf16 v[44:47], a[12:15], v[120:123], 0
    ds_read_b64_tr_b16 a[78:79], v223 offset:2048
    s_sub_u32 s52, 64, s52
    v_mfma_f32_16x16x32_bf16 v[44:47], a[28:31], v[124:127], v[44:47]
    ds_read_b64_tr_b16 a[80:81], v22 offset:16384
    s_mul_i32 s52, s52, s51
    v_mfma_f32_16x16x32_bf16 v[32:35], a[0:3], v[120:123], 0
    ds_read_b64_tr_b16 a[82:83], v22 offset:18432
    s_lshl_b32 s51, s51, 257
    v_mfma_f32_16x16x32_bf16 v[32:35], a[16:19], v[124:127], v[32:35]
    buffer_load_dwordx4 v[116:119], v8, s[20:23], s71 offen sc1
    v_mfma_f32_16x16x32_bf16 v[36:39], a[4:7], v[120:123], 0
    ds_read_b64_tr_b16 a[84:85], v23 offset:16384
    s_sub_u32 s51, 1, s51
    v_mfma_f32_16x16x32_bf16 v[36:39], a[20:23], v[124:127], v[36:39]
    ds_read_b64_tr_b16 a[86:87], v23 offset:18432
    s_waitcnt vmcnt(10)
    v_mfma_f32_16x16x32_bf16 v[56:59], a[40:43], v[128:131], v[56:59]
    ds_read_b64_tr_b16 a[88:89], v24 offset:16384
    s_and_b32 s53, s38, 1
    v_mfma_f32_16x16x32_bf16 v[56:59], a[56:59], v[132:135], v[56:59]
    buffer_load_dwordx4 v[120:123], v9, s[20:23], s72 offen sc1
    v_mfma_f32_16x16x32_bf16 v[60:63], a[44:47], v[128:131], v[60:63]
    ds_read_b64_tr_b16 a[90:91], v24 offset:18432
    s_lshl_b32 s53, s53, 5
    v_mfma_f32_16x16x32_bf16 v[60:63], a[60:63], v[132:135], v[60:63]
    ds_read_b64_tr_b16 a[92:93], v25 offset:16384
    v_and_b32_e64 v224, 15, v0
    v_mfma_f32_16x16x32_bf16 v[48:51], a[32:35], v[128:131], v[48:51]
    ds_read_b64_tr_b16 a[94:95], v25 offset:18432
    v_lshl_add_u32 v224, v224, 1, s53
    v_mfma_f32_16x16x32_bf16 v[48:51], a[48:51], v[132:135], v[48:51]
    buffer_load_dwordx4 v[124:127], v9, s[20:23], s73 offen sc1
    v_mfma_f32_16x16x32_bf16 v[52:55], a[36:39], v[128:131], v[52:55]
    ds_read_b64_tr_b16 a[96:97], v22 offset:32768
    v_mul_lo_u32 v224, v224, s51
    v_mfma_f32_16x16x32_bf16 v[52:55], a[52:55], v[132:135], v[52:55]
    ds_read_b64_tr_b16 a[98:99], v22 offset:34816
    s_waitcnt vmcnt(10)
    v_mfma_f32_16x16x32_bf16 v[40:43], a[40:43], v[136:139], v[40:43]
    ds_read_b64_tr_b16 a[100:101], v23 offset:32768
    v_add_u32 v224, s52, v224
    v_mfma_f32_16x16x32_bf16 v[40:43], a[56:59], v[140:143], v[40:43]
    buffer_load_dwordx4 v[128:131], v8, s[20:23], s72 offen sc1
    v_mfma_f32_16x16x32_bf16 v[44:47], a[44:47], v[136:139], v[44:47]
    ds_read_b64_tr_b16 a[102:103], v23 offset:34816
    v_lshrrev_b32_e64 v225, 4, v0
    v_mfma_f32_16x16x32_bf16 v[44:47], a[60:63], v[140:143], v[44:47]
    ds_read_b64_tr_b16 a[104:105], v24 offset:32768
    v_lshlrev_b32_e64 v225, 1, v225
    v_mfma_f32_16x16x32_bf16 v[32:35], a[32:35], v[136:139], v[32:35]
    ds_read_b64_tr_b16 a[106:107], v24 offset:34816
    s_mov_b64 s[98:99], 0xffff
    v_mfma_f32_16x16x32_bf16 v[32:35], a[48:51], v[140:143], v[32:35]
    buffer_load_dwordx4 v[132:135], v8, s[20:23], s73 offen sc1
    v_mfma_f32_16x16x32_bf16 v[36:39], a[36:39], v[136:139], v[36:39]
    ds_read_b64_tr_b16 a[108:109], v25 offset:32768
    v_cndmask_b32 v232, v225, 16, s[98:99]
    v_mfma_f32_16x16x32_bf16 v[36:39], a[52:55], v[140:143], v[36:39]
    ds_read_b64_tr_b16 a[110:111], v25 offset:34816
    s_waitcnt vmcnt(10)
    v_mfma_f32_16x16x32_bf16 v[56:59], a[200:203], v[144:147], v[56:59]
    ds_read_b64_tr_b16 a[112:113], v220 offset:16384
    v_cvt_f32_u32 v225, v225
    v_mfma_f32_16x16x32_bf16 v[56:59], a[216:219], v[148:151], v[56:59]
    buffer_load_dwordx4 v[136:139], v9, s[20:23], s74 offen sc1
    v_mfma_f32_16x16x32_bf16 v[60:63], a[204:207], v[144:147], v[60:63]
    ds_read_b64_tr_b16 a[114:115], v220 offset:18432
    v_cvt_f32_u32_e64 v232, v232
    v_mfma_f32_16x16x32_bf16 v[60:63], a[220:223], v[148:151], v[60:63]
    ds_read_b64_tr_b16 a[116:117], v221 offset:16384
    s_and_b32 s52, s52, 1
    v_mfma_f32_16x16x32_bf16 v[48:51], a[192:195], v[144:147], v[48:51]
    ds_read_b64_tr_b16 a[118:119], v221 offset:18432
    s_lshl_b32 s52, s52, 4
    v_mfma_f32_16x16x32_bf16 v[48:51], a[208:211], v[148:151], v[48:51]
    buffer_load_dwordx4 v[140:143], v9, s[20:23], s75 offen sc1
    v_mfma_f32_16x16x32_bf16 v[52:55], a[196:199], v[144:147], v[52:55]
    ds_read_b64_tr_b16 a[120:121], v222 offset:16384
    s_load_dword s96, s[20:21], s59 glc
    v_mfma_f32_16x16x32_bf16 v[52:55], a[212:215], v[148:151], v[52:55]
    ds_read_b64_tr_b16 a[122:123], v222 offset:18432
    s_waitcnt vmcnt(10)
    v_mfma_f32_16x16x32_bf16 v[40:43], a[200:203], v[152:155], v[40:43]
    ds_read_b64_tr_b16 a[124:125], v223 offset:16384
    s_lshr_b32 s54, 0x80000000, s52
    v_mfma_f32_16x16x32_bf16 v[40:43], a[216:219], v[156:159], v[40:43]
    buffer_load_dwordx4 v[144:147], v8, s[20:23], s74 offen sc1
    v_mfma_f32_16x16x32_bf16 v[44:47], a[204:207], v[152:155], v[44:47]
    ds_read_b64_tr_b16 a[126:127], v223 offset:18432
    s_lshl_b32 s53, 0x3f80, s52
    v_mfma_f32_16x16x32_bf16 v[44:47], a[220:223], v[156:159], v[44:47]
    ds_read_b64_tr_b16 a[128:129], v22 offset:0
    v_cvt_f32_u32 v226, v224
    v_mfma_f32_16x16x32_bf16 v[32:35], a[192:195], v[152:155], v[32:35]
    ds_read_b64_tr_b16 a[130:131], v22 offset:2048
    v_mov_b32_e64 v233, s53
    v_mfma_f32_16x16x32_bf16 v[32:35], a[208:211], v[156:159], v[32:35]
    buffer_load_dwordx4 v[148:151], v8, s[20:23], s75 offen sc1
    v_mfma_f32_16x16x32_bf16 v[36:39], a[196:199], v[152:155], v[36:39]
    ds_read_b64_tr_b16 a[132:133], v23 offset:0
    v_mul_f32 v226, 0x3c800000, v226
    v_mfma_f32_16x16x32_bf16 v[36:39], a[212:215], v[156:159], v[36:39]
    ds_read_b64_tr_b16 a[134:135], v23 offset:2048
    s_waitcnt vmcnt(10)
    v_mfma_f32_16x16x32_bf16 v[56:59], a[232:235], v[160:163], v[56:59]
    ds_read_b64_tr_b16 a[136:137], v24 offset:0
    v_mul_f32 v227, v225, v226
    v_mfma_f32_16x16x32_bf16 v[56:59], a[248:251], v[164:167], v[56:59]
    buffer_load_dwordx4 v[152:155], v9, s[20:23], s76 offen sc1
    v_mfma_f32_16x16x32_bf16 v[60:63], a[236:239], v[160:163], v[60:63]
    ds_read_b64_tr_b16 a[138:139], v24 offset:2048
    v_mul_f32_e64 v229, v232, v226
    v_mfma_f32_16x16x32_bf16 v[60:63], a[252:255], v[164:167], v[60:63]
    ds_read_b64_tr_b16 a[140:141], v25 offset:0
    v_fmamk_f32 v231, v226, 0x3f800000, v227
    v_mfma_f32_16x16x32_bf16 v[48:51], a[224:227], v[160:163], v[48:51]
    ds_read_b64_tr_b16 a[142:143], v25 offset:2048
    v_mfma_f32_16x16x32_bf16 v[48:51], a[240:243], v[164:167], v[48:51]
    buffer_load_dwordx4 v[156:159], v9, s[20:23], s77 offen sc1
    v_mfma_f32_16x16x32_bf16 v[52:55], a[228:231], v[160:163], v[52:55]
    ds_read_b64_tr_b16 a[144:145], v22 offset:49152
    v_mfma_f32_16x16x32_bf16 v[52:55], a[244:247], v[164:167], v[52:55]
    ds_read_b64_tr_b16 a[146:147], v22 offset:51200
    s_waitcnt vmcnt(10)
    v_mfma_f32_16x16x32_bf16 v[40:43], a[232:235], v[112:115], v[40:43]
    v_cos_f32 v228, v229
    v_mfma_f32_16x16x32_bf16 v[40:43], a[248:251], v[116:119], v[40:43]
    buffer_load_dwordx4 v[160:163], v8, s[20:23], s76 offen sc1
    v_mfma_f32_16x16x32_bf16 v[44:47], a[236:239], v[112:115], v[44:47]
    v_sin_f32 v229, v229
    v_mfma_f32_16x16x32_bf16 v[44:47], a[252:255], v[116:119], v[44:47]
    v_cos_f32 v230, v231
    v_mfma_f32_16x16x32_bf16 v[32:35], a[224:227], v[112:115], v[32:35]
    v_sin_f32_e64 v231, v231
    v_mfma_f32_16x16x32_bf16 v[32:35], a[240:243], v[116:119], v[32:35]
    buffer_load_dwordx4 v[164:167], v8, s[20:23], s77 offen sc1
    v_mfma_f32_16x16x32_bf16 v[36:39], a[228:231], v[112:115], v[36:39]
    s_waitcnt lgkmcnt(0)
    s_cmp_lt_i32 s96, 3
    s_cbranch_scc1 fl1_slow
fl1_back:
    v_cvt_pk_bf16_f32 v204, v228, v229
    v_mfma_f32_16x16x32_bf16 v[36:39], a[244:247], v[116:119], v[36:39]
    ds_read_b64_tr_b16 a[148:149], v23 offset:49152
    s_waitcnt vmcnt(10) lgkmcnt(15)
    v_mfma_f32_16x16x32_bf16 v[56:59], a[72:75], v[120:123], v[56:59]
    ds_read_b64_tr_b16 a[150:151], v23 offset:51200
    v_cvt_pk_bf16_f32 v206, v230, v231
    v_mfma_f32_16x16x32_bf16 v[56:59], a[88:91], v[124:127], v[56:59]
    buffer_load_dwordx4 v[112:115], v11, s[20:23], s64 offen sc1
    v_mfma_f32_16x16x32_bf16 v[60:63], a[76:79], v[120:123], v[60:63]
    ds_read_b64_tr_b16 a[152:153], v24 offset:49152
    v_xor_b32_e64 v205, s54, v204
    v_mfma_f32_16x16x32_bf16 v[60:63], a[92:95], v[124:127], v[60:63]
    ds_read_b64_tr_b16 a[154:155], v24 offset:51200
    v_xor_b32_e64 v207, s54, v206
    v_mfma_f32_16x16x32_bf16 v[48:51], a[64:67], v[120:123], v[48:51]
    ds_read_b64_tr_b16 a[156:157], v25 offset:49152
    v_cndmask_b32 v204, v204, v233, s[98:99]
    v_mfma_f32_16x16x32_bf16 v[48:51], a[80:83], v[124:127], v[48:51]
    buffer_load_dwordx4 v[116:119], v11, s[20:23], s65 offen sc1
    v_mfma_f32_16x16x32_bf16 v[52:55], a[68:71], v[120:123], v[52:55]
    ds_read_b64_tr_b16 a[158:159], v25 offset:51200
    v_fmamk_f32 v229, v226, 0x41000000, v227
    v_mfma_f32_16x16x32_bf16 v[52:55], a[84:87], v[124:127], v[52:55]
    s_waitcnt vmcnt(10)
    v_fmamk_f32 v231, v226, 0x41100000, v227
    v_mfma_f32_16x16x32_bf16 v[40:43], a[72:75], v[128:131], v[40:43]
    v_cos_f32 v228, v229
    v_mfma_f32_16x16x32_bf16 v[40:43], a[88:91], v[132:135], v[40:43]
    buffer_load_dwordx4 v[120:123], v11, s[20:23], s66 offen sc1
    v_mfma_f32_16x16x32_bf16 v[44:47], a[76:79], v[128:131], v[44:47]
    v_sin_f32 v229, v229
    v_mfma_f32_16x16x32_bf16 v[44:47], a[92:95], v[132:135], v[44:47]
    v_cos_f32 v230, v231
    v_mfma_f32_16x16x32_bf16 v[32:35], a[64:67], v[128:131], v[32:35]
    v_sin_f32_e64 v231, v231
    v_mfma_f32_16x16x32_bf16 v[32:35], a[80:83], v[132:135], v[32:35]
    buffer_load_dwordx4 v[124:127], v11, s[20:23], s67 offen sc1
    v_mfma_f32_16x16x32_bf16 v[36:39], a[68:71], v[128:131], v[36:39]
    v_cvt_pk_bf16_f32 v208, v228, v229
    v_cvt_pk_bf16_f32 v210, v230, v231
    v_mfma_f32_16x16x32_bf16 v[36:39], a[84:87], v[132:135], v[36:39]
    s_waitcnt vmcnt(10) lgkmcnt(15)
    v_xor_b32 v209, s54, v208
    v_xor_b32 v211, s54, v210
    v_mfma_f32_16x16x32_bf16 v[56:59], a[104:107], v[136:139], v[56:59]
    v_add_u32 v224, s51, v224
    v_mfma_f32_16x16x32_bf16 v[56:59], a[120:123], v[140:143], v[56:59]
    buffer_load_dwordx4 v[128:131], v11, s[20:23], s68 offen sc1
    v_mfma_f32_16x16x32_bf16 v[60:63], a[108:111], v[136:139], v[60:63]
    s_xor_b32 s54, s54, 0x80008000
    s_xor_b32 s53, s53, 0x3f803f80
    v_cvt_f32_u32 v226, v224
    v_mfma_f32_16x16x32_bf16 v[60:63], a[124:127], v[140:143], v[60:63]
    v_mov_b32 v233, s53
    v_mul_f32 v226, 0x3c800000, v226
    v_mfma_f32_16x16x32_bf16 v[48:51], a[96:99], v[136:139], v[48:51]
    v_mul_f32 v227, v225, v226
    v_mul_f32 v229, v232, v226
    v_mfma_f32_16x16x32_bf16 v[48:51], a[112:115], v[140:143], v[48:51]
    buffer_load_dwordx4 v[132:135], v11, s[20:23], s69 offen sc1
    v_mfma_f32_16x16x32_bf16 v[52:55], a[100:103], v[136:139], v[52:55]
    v_fmamk_f32 v231, v226, 0x3f800000, v227
    v_mfma_f32_16x16x32_bf16 v[52:55], a[116:119], v[140:143], v[52:55]
    s_waitcnt vmcnt(10)
    v_cos_f32 v228, v229
    v_mfma_f32_16x16x32_bf16 v[40:43], a[104:107], v[144:147], v[40:43]
    v_sin_f32_e64 v229, v229
    v_mfma_f32_16x16x32_bf16 v[40:43], a[120:123], v[148:151], v[40:43]
    buffer_load_dwordx4 v[136:139], v11, s[20:23], s70 offen sc1
    v_mfma_f32_16x16x32_bf16 v[44:47], a[108:111], v[144:147], v[44:47]
    v_cos_f32 v230, v231
    v_mfma_f32_16x16x32_bf16 v[44:47], a[124:127], v[148:151], v[44:47]
    v_sin_f32 v231, v231
    v_mfma_f32_16x16x32_bf16 v[32:35], a[96:99], v[144:147], v[32:35]
    v_cvt_pk_bf16_f32 v212, v228, v229
    v_cvt_pk_bf16_f32 v214, v230, v231
    v_mfma_f32_16x16x32_bf16 v[32:35], a[112:115], v[148:151], v[32:35]
    buffer_load_dwordx4 v[140:143], v11, s[20:23], s71 offen sc1
    v_mfma_f32_16x16x32_bf16 v[36:39], a[100:103], v[144:147], v[36:39]
    v_xor_b32 v213, s54, v212
    v_xor_b32 v215, s54, v214
    v_mfma_f32_16x16x32_bf16 v[36:39], a[116:119], v[148:151], v[36:39]
    s_waitcnt vmcnt(10) lgkmcnt(0)
    v_cndmask_b32 v212, v212, v233, s[98:99]
    v_fmamk_f32 v229, v226, 0x41000000, v227
    v_mfma_f32_16x16x32_bf16 v[56:59], a[136:139], v[152:155], v[56:59]
    v_fmamk_f32 v231, v226, 0x41100000, v227
    v_mfma_f32_16x16x32_bf16 v[56:59], a[152:155], v[156:159], v[56:59]
    buffer_load_dwordx4 v[144:147], v11, s[20:23], s72 offen sc1
    v_mfma_f32_16x16x32_bf16 v[60:63], a[140:143], v[152:155], v[60:63]
    v_cos_f32 v228, v229
    v_mfma_f32_16x16x32_bf16 v[60:63], a[156:159], v[156:159], v[60:63]
    v_sin_f32 v229, v229
    v_mfma_f32_16x16x32_bf16 v[48:51], a[128:131], v[152:155], v[48:51]
    v_cos_f32 v230, v231
    v_mfma_f32_16x16x32_bf16 v[48:51], a[144:147], v[156:159], v[48:51]
    buffer_load_dwordx4 v[148:151], v11, s[20:23], s73 offen sc1
    v_mfma_f32_16x16x32_bf16 v[52:55], a[132:135], v[152:155], v[52:55]
    v_sin_f32 v231, v231
    v_mfma_f32_16x16x32_bf16 v[52:55], a[148:151], v[156:159], v[52:55]
    s_waitcnt vmcnt(10)
    v_cvt_pk_bf16_f32 v216, v228, v229
    v_cvt_pk_bf16_f32 v218, v230, v231
    v_mfma_f32_16x16x32_bf16 v[40:43], a[136:139], v[160:163], v[40:43]
    v_xor_b32 v217, s54, v216
    v_xor_b32 v219, s54, v218
    v_mfma_f32_16x16x32_bf16 v[40:43], a[152:155], v[164:167], v[40:43]
    buffer_load_dwordx4 v[152:155], v11, s[20:23], s74 offen sc1
    v_mfma_f32_16x16x32_bf16 v[44:47], a[140:143], v[160:163], v[44:47]
    s_mov_b32 s51, 0xbfb8aa3b
    v_permlane16_swap_b32 v196, v198
    v_mfma_f32_16x16x32_bf16 v[44:47], a[156:159], v[164:167], v[44:47]
    v_permlane16_swap_b32 v197, v199
    v_mfma_f32_16x16x32_bf16 v[32:35], a[128:131], v[160:163], v[32:35]
    ds_write_b128 v18, v[56:59] offset:32768
    v_mfma_f32_16x16x32_bf16 v[32:35], a[144:147], v[164:167], v[32:35]
    buffer_load_dwordx4 v[156:159], v11, s[20:23], s75 offen sc1
    v_mfma_f32_16x16x32_bf16 v[36:39], a[132:135], v[160:163], v[36:39]
    v_lshlrev_b32_e64 v184, 16, v196
    v_and_b32 v185, 0xffff0000, v196
    v_mfma_f32_16x16x32_bf16 v[36:39], a[148:151], v[164:167], v[36:39]
    s_waitcnt vmcnt(10)
    v_lshlrev_b32 v186, 16, v197
    v_and_b32 v187, 0xffff0000, v197
    v_mfma_f32_16x16x32_bf16 v[88:91], a[8:11], v[112:115], 0
    ds_write_b128 v18, v[60:63] offset:33792
    v_mfma_f32_16x16x32_bf16 v[88:91], a[24:27], v[116:119], v[88:91]
    buffer_load_dwordx4 v[160:163], v11, s[20:23], s76 offen sc1
    v_mfma_f32_16x16x32_bf16 v[92:95], a[12:15], v[112:115], 0
    v_lshlrev_b32_e64 v188, 16, v198
    v_and_b32 v189, 0xffff0000, v198
    v_mfma_f32_16x16x32_bf16 v[92:95], a[28:31], v[116:119], v[92:95]
    v_lshlrev_b32_e64 v190, 16, v199
    v_and_b32 v191, 0xffff0000, v199
    v_mfma_f32_16x16x32_bf16 v[80:83], a[0:3], v[112:115], 0
    ds_write_b128 v18, v[48:51] offset:0
    v_mfma_f32_16x16x32_bf16 v[80:83], a[16:19], v[116:119], v[80:83]
    buffer_load_dwordx4 v[164:167], v11, s[20:23], s77 offen sc1
    v_mfma_f32_16x16x32_bf16 v[84:87], a[4:7], v[112:115], 0
    v_permlane16_swap_b32 v200, v202
    v_mfma_f32_16x16x32_bf16 v[84:87], a[20:23], v[116:119], v[84:87]
    s_waitcnt vmcnt(10)
    v_permlane16_swap_b32_e64 v201, v203
    v_mfma_f32_16x16x32_bf16 v[88:91], a[40:43], v[120:123], v[88:91]
    ds_write_b128 v18, v[52:55] offset:1024
    v_mfma_f32_16x16x32_bf16 v[88:91], a[56:59], v[124:127], v[88:91]
    buffer_load_dwordx4 v[112:115], v10, s[20:23], s64 offen sc1
    v_mfma_f32_16x16x32_bf16 v[92:95], a[44:47], v[120:123], v[92:95]
    v_lshlrev_b32_e64 v244, 16, v200
    v_and_b32 v245, 0xffff0000, v200
    v_mfma_f32_16x16x32_bf16 v[92:95], a[60:63], v[124:127], v[92:95]
    v_lshlrev_b32_e64 v246, 16, v201
    v_and_b32 v247, 0xffff0000, v201
    v_mfma_f32_16x16x32_bf16 v[80:83], a[32:35], v[120:123], v[80:83]
    ds_write_b128 v18, v[40:43] offset:16384
    v_mfma_f32_16x16x32_bf16 v[80:83], a[48:51], v[124:127], v[80:83]
    buffer_load_dwordx4 v[116:119], v10, s[20:23], s65 offen sc1
    v_mfma_f32_16x16x32_bf16 v[84:87], a[36:39], v[120:123], v[84:87]
    v_lshlrev_b32_e64 v248, 16, v202
    v_and_b32 v249, 0xffff0000, v202
    v_mfma_f32_16x16x32_bf16 v[84:87], a[52:55], v[124:127], v[84:87]
    s_waitcnt vmcnt(10)
    v_lshlrev_b32 v250, 16, v203
    v_and_b32 v251, 0xffff0000, v203
    v_mfma_f32_16x16x32_bf16 v[88:91], a[200:203], v[128:131], v[88:91]
    ds_write_b128 v18, v[44:47] offset:17408
    v_mfma_f32_16x16x32_bf16 v[88:91], a[216:219], v[132:135], v[88:91]
    buffer_load_dwordx4 v[120:123], v10, s[20:23], s66 offen sc1
    v_mfma_f32_16x16x32_bf16 v[92:95], a[204:207], v[128:131], v[92:95]
    v_mfma_f32_16x16x32_bf16 v[92:95], a[220:223], v[132:135], v[92:95]
    v_mfma_f32_16x16x32_bf16 v[80:83], a[192:195], v[128:131], v[80:83]
    v_mfma_f32_16x16x32_bf16 v[80:83], a[208:211], v[132:135], v[80:83]
    buffer_load_dwordx4 v[124:127], v10, s[20:23], s67 offen sc1
    v_mfma_f32_16x16x32_bf16 v[84:87], a[196:199], v[128:131], v[84:87]
    s_waitcnt lgkmcnt(0)
    s_barrier
    v_mfma_f32_16x16x32_bf16 v[84:87], a[212:215], v[132:135], v[84:87]
    ds_read_b128 v[220:223], v19 offset:0
    s_waitcnt vmcnt(10)
    v_mfma_f32_16x16x32_bf16 v[88:91], a[232:235], v[136:139], v[88:91]
    ds_read_b128 v[224:227], v19 offset:1024
    v_mfma_f32_16x16x32_bf16 v[88:91], a[248:251], v[140:143], v[88:91]
    buffer_load_dwordx4 v[128:131], v10, s[20:23], s68 offen sc1
    v_mfma_f32_16x16x32_bf16 v[92:95], a[236:239], v[136:139], v[92:95]
    ds_read_b128 v[228:231], v20 offset:16384
    v_mfma_f32_16x16x32_bf16 v[92:95], a[252:255], v[140:143], v[92:95]
    ds_read_b128 v[232:235], v20 offset:17408
    v_mfma_f32_16x16x32_bf16 v[80:83], a[224:227], v[136:139], v[80:83]
    ds_read_b128 v[236:239], v21 offset:32768
    v_mfma_f32_16x16x32_bf16 v[80:83], a[240:243], v[140:143], v[80:83]
    buffer_load_dwordx4 v[132:135], v10, s[20:23], s69 offen sc1
    v_mfma_f32_16x16x32_bf16 v[84:87], a[228:231], v[136:139], v[84:87]
    ds_read_b128 v[240:243], v21 offset:33792
    v_mfma_f32_16x16x32_bf16 v[84:87], a[244:247], v[140:143], v[84:87]
    s_waitcnt vmcnt(10)
    v_mfma_f32_16x16x32_bf16 v[88:91], a[72:75], v[144:147], v[88:91]
    v_mfma_f32_16x16x32_bf16 v[88:91], a[88:91], v[148:151], v[88:91]
    buffer_load_dwordx4 v[136:139], v10, s[20:23], s70 offen sc1
    v_mfma_f32_16x16x32_bf16 v[92:95], a[76:79], v[144:147], v[92:95]
    v_mfma_f32_16x16x32_bf16 v[92:95], a[92:95], v[148:151], v[92:95]
    s_waitcnt lgkmcnt(0)
    v_add_f32 v32, v32, v220
    v_add_f32_e64 v33, v33, v221
    v_mfma_f32_16x16x32_bf16 v[80:83], a[64:67], v[144:147], v[80:83]
    s_load_dword s96, s[32:33], 64
    v_add_f32 v34, v34, v222
    v_add_f32 v35, v35, v223
    v_mfma_f32_16x16x32_bf16 v[80:83], a[80:83], v[148:151], v[80:83]
    buffer_load_dwordx4 v[140:143], v10, s[20:23], s71 offen sc1
    v_mfma_f32_16x16x32_bf16 v[84:87], a[68:71], v[144:147], v[84:87]
    s_load_dword s97, s[32:33], 128
    v_add_f32 v36, v36, v224
    v_add_f32 v37, v37, v225
    v_mfma_f32_16x16x32_bf16 v[84:87], a[84:87], v[148:151], v[84:87]
    s_waitcnt vmcnt(10)
    v_add_f32 v38, v38, v226
    v_add_f32 v39, v39, v227
    v_mfma_f32_16x16x32_bf16 v[88:91], a[104:107], v[152:155], v[88:91]
    v_add_f32 v228, v228, v236
    v_add_f32_e64 v229, v229, v237
    v_mfma_f32_16x16x32_bf16 v[88:91], a[120:123], v[156:159], v[88:91]
    buffer_load_dwordx4 v[144:147], v10, s[20:23], s72 offen sc1
    v_mfma_f32_16x16x32_bf16 v[92:95], a[108:111], v[152:155], v[92:95]
    v_add_f32 v230, v230, v238
    v_add_f32 v231, v231, v239
    v_mfma_f32_16x16x32_bf16 v[92:95], a[124:127], v[156:159], v[92:95]
    v_add_f32 v232, v232, v240
    v_add_f32 v233, v233, v241
    v_mfma_f32_16x16x32_bf16 v[80:83], a[96:99], v[152:155], v[80:83]
    v_add_f32 v234, v234, v242
    v_add_f32 v235, v235, v243
    v_mfma_f32_16x16x32_bf16 v[80:83], a[112:115], v[156:159], v[80:83]
    buffer_load_dwordx4 v[148:151], v10, s[20:23], s73 offen sc1
    v_mfma_f32_16x16x32_bf16 v[84:87], a[100:103], v[152:155], v[84:87]
    v_add_f32 v32, v32, v228
    v_add_f32 v33, v33, v229
    v_mfma_f32_16x16x32_bf16 v[84:87], a[116:119], v[156:159], v[84:87]
    s_waitcnt vmcnt(10)
    v_add_f32 v34, v34, v230
    v_add_f32 v35, v35, v231
    v_mfma_f32_16x16x32_bf16 v[88:91], a[136:139], v[160:163], v[88:91]
    v_add_f32 v36, v36, v232
    v_add_f32_e64 v37, v37, v233
    v_mfma_f32_16x16x32_bf16 v[88:91], a[152:155], v[164:167], v[88:91]
    buffer_load_dwordx4 v[152:155], v10, s[20:23], s74 offen sc1
    v_mfma_f32_16x16x32_bf16 v[92:95], a[140:143], v[160:163], v[92:95]
    v_add_f32 v38, v38, v234
    v_add_f32 v39, v39, v235
    v_mfma_f32_16x16x32_bf16 v[92:95], a[156:159], v[164:167], v[92:95]
    v_mul_f32 v220, s51, v32
    v_mul_f32 v221, s51, v33
    v_mfma_f32_16x16x32_bf16 v[80:83], a[128:131], v[160:163], v[80:83]
    v_mul_f32 v222, s51, v34
    v_mul_f32 v223, s51, v35
    v_mfma_f32_16x16x32_bf16 v[80:83], a[144:147], v[164:167], v[80:83]
    buffer_load_dwordx4 v[156:159], v10, s[20:23], s75 offen sc1
    v_mfma_f32_16x16x32_bf16 v[84:87], a[132:135], v[160:163], v[84:87]
    v_mul_f32 v224, s51, v36
    v_mul_f32 v225, s51, v37
    v_mfma_f32_16x16x32_bf16 v[84:87], a[148:151], v[164:167], v[84:87]
    s_waitcnt vmcnt(10)
    v_mul_f32 v226, s51, v38
    v_mul_f32 v227, s51, v39
    v_mfma_f32_16x16x32_bf16 v[72:75], a[8:11], v[112:115], 0
    v_exp_f32 v220, v220
    v_mfma_f32_16x16x32_bf16 v[72:75], a[24:27], v[116:119], v[72:75]
    buffer_load_dwordx4 v[160:163], v10, s[20:23], s76 offen sc1
    v_mfma_f32_16x16x32_bf16 v[76:79], a[12:15], v[112:115], 0
    ds_write_b128 v18, v[88:91] offset:34816
    v_mfma_f32_16x16x32_bf16 v[76:79], a[28:31], v[116:119], v[76:79]
    v_exp_f32 v221, v221
    v_mfma_f32_16x16x32_bf16 v[64:67], a[0:3], v[112:115], 0
    v_exp_f32 v222, v222
    v_mfma_f32_16x16x32_bf16 v[64:67], a[16:19], v[116:119], v[64:67]
    buffer_load_dwordx4 v[164:167], v10, s[20:23], s77 offen sc1
    v_mfma_f32_16x16x32_bf16 v[68:71], a[4:7], v[112:115], 0
    s_waitcnt lgkmcnt(0)
    s_min_i32 s96, s96, s97
    s_cmp_lt_i32 s96, 16
    s_cbranch_scc1 zf_slow
zf_back:
    v_mfma_f32_16x16x32_bf16 v[68:71], a[20:23], v[116:119], v[68:71]
    s_waitcnt vmcnt(10)
    v_exp_f32 v223, v223
    v_mfma_f32_16x16x32_bf16 v[72:75], a[40:43], v[120:123], v[72:75]
    ds_write_b128 v18, v[92:95] offset:35840
    v_mfma_f32_16x16x32_bf16 v[72:75], a[56:59], v[124:127], v[72:75]
    buffer_load_dwordx2 v[168:169], v252, s[20:23], s100 offen offset:0 sc1
    v_mfma_f32_16x16x32_bf16 v[76:79], a[44:47], v[120:123], v[76:79]
    v_exp_f32_e64 v224, v224
    v_mfma_f32_16x16x32_bf16 v[76:79], a[60:63], v[124:127], v[76:79]
    ds_write_b128 v18, v[80:83] offset:2048
    v_mfma_f32_16x16x32_bf16 v[64:67], a[32:35], v[120:123], v[64:67]
    v_exp_f32_e64 v225, v225
    v_mfma_f32_16x16x32_bf16 v[64:67], a[48:51], v[124:127], v[64:67]
    buffer_load_dwordx2 v[170:171], v252, s[20:23], s100 offen offset:2176 sc1
    v_mfma_f32_16x16x32_bf16 v[68:71], a[36:39], v[120:123], v[68:71]
    ds_write_b128 v18, v[84:87] offset:3072
    v_mfma_f32_16x16x32_bf16 v[68:71], a[52:55], v[124:127], v[68:71]
    s_waitcnt vmcnt(10)
    v_exp_f32 v226, v226
    v_mfma_f32_16x16x32_bf16 v[72:75], a[200:203], v[128:131], v[72:75]
    v_exp_f32_e64 v227, v227
    v_mfma_f32_16x16x32_bf16 v[72:75], a[216:219], v[132:135], v[72:75]
    buffer_load_dwordx2 v[172:173], v253, s[20:23], s100 offen offset:0 sc1
    v_mfma_f32_16x16x32_bf16 v[76:79], a[204:207], v[128:131], v[76:79]
    v_add_f32 v220, 1.0, v220
    v_add_f32 v221, 1.0, v221
    v_mfma_f32_16x16x32_bf16 v[76:79], a[220:223], v[132:135], v[76:79]
    v_add_f32 v222, 1.0, v222
    v_add_f32 v223, 1.0, v223
    v_mfma_f32_16x16x32_bf16 v[64:67], a[192:195], v[128:131], v[64:67]
    s_waitcnt lgkmcnt(0)
    s_barrier
    v_add_f32_e64 v224, 1.0, v224
    v_mfma_f32_16x16x32_bf16 v[64:67], a[208:211], v[132:135], v[64:67]
    buffer_load_dwordx2 v[174:175], v253, s[20:23], s100 offen offset:2176 sc1
    v_mfma_f32_16x16x32_bf16 v[68:71], a[196:199], v[128:131], v[68:71]
    ds_read_b128 v[48:51], v19 offset:2048
    v_add_f32_e64 v225, 1.0, v225
    v_mfma_f32_16x16x32_bf16 v[68:71], a[212:215], v[132:135], v[68:71]
    ds_read_b128 v[52:55], v19 offset:3072
    s_waitcnt vmcnt(10)
    v_mfma_f32_16x16x32_bf16 v[72:75], a[232:235], v[136:139], v[72:75]
    ds_read_b128 v[56:59], v21 offset:34816
    v_add_f32 v226, 1.0, v226
    v_mfma_f32_16x16x32_bf16 v[72:75], a[248:251], v[140:143], v[72:75]
    buffer_load_dwordx2 v[176:177], v252, s[20:23], s101 offen offset:0 sc1
    v_mfma_f32_16x16x32_bf16 v[76:79], a[236:239], v[136:139], v[76:79]
    ds_read_b128 v[60:63], v21 offset:35840
    v_add_f32 v227, 1.0, v227
    v_mfma_f32_16x16x32_bf16 v[76:79], a[252:255], v[140:143], v[76:79]
    v_rcp_f32 v220, v220
    v_mfma_f32_16x16x32_bf16 v[64:67], a[224:227], v[136:139], v[64:67]
    v_rcp_f32_e64 v221, v221
    v_mfma_f32_16x16x32_bf16 v[64:67], a[240:243], v[140:143], v[64:67]
    buffer_load_dwordx2 v[178:179], v252, s[20:23], s101 offen offset:2176 sc1
    v_mfma_f32_16x16x32_bf16 v[68:71], a[228:231], v[136:139], v[68:71]
    v_rcp_f32 v222, v222
    v_mfma_f32_16x16x32_bf16 v[68:71], a[244:247], v[140:143], v[68:71]
    s_waitcnt vmcnt(10)
    v_rcp_f32 v223, v223
    v_mfma_f32_16x16x32_bf16 v[72:75], a[72:75], v[144:147], v[72:75]
    s_waitcnt lgkmcnt(0)
    v_add_f32 v48, v48, v56
    v_add_f32 v49, v49, v57
    v_mfma_f32_16x16x32_bf16 v[72:75], a[88:91], v[148:151], v[72:75]
    buffer_load_dwordx2 v[180:181], v253, s[20:23], s101 offen offset:0 sc1
    v_mfma_f32_16x16x32_bf16 v[76:79], a[76:79], v[144:147], v[76:79]
    v_add_f32 v50, v50, v58
    v_add_f32 v51, v51, v59
    v_mfma_f32_16x16x32_bf16 v[76:79], a[92:95], v[148:151], v[76:79]
    v_add_f32 v52, v52, v60
    v_add_f32 v53, v53, v61
    v_mfma_f32_16x16x32_bf16 v[64:67], a[64:67], v[144:147], v[64:67]
    v_add_f32 v54, v54, v62
    v_add_f32 v55, v55, v63
    v_mfma_f32_16x16x32_bf16 v[64:67], a[80:83], v[148:151], v[64:67]
    buffer_load_dwordx2 v[182:183], v253, s[20:23], s101 offen offset:2176 sc1
    v_mfma_f32_16x16x32_bf16 v[68:71], a[68:71], v[144:147], v[68:71]
    s_mov_b32 s52, s51
    s_mov_b32 s53, s51
    v_mfma_f32_16x16x32_bf16 v[68:71], a[84:87], v[148:151], v[68:71]
    s_waitcnt vmcnt(10)
    v_rcp_f32 v224, v224
    v_mfma_f32_16x16x32_bf16 v[72:75], a[104:107], v[152:155], v[72:75]
    v_rcp_f32 v225, v225
    v_mfma_f32_16x16x32_bf16 v[72:75], a[120:123], v[156:159], v[72:75]
    v_rcp_f32 v226, v226
    v_mfma_f32_16x16x32_bf16 v[76:79], a[108:111], v[152:155], v[76:79]
    v_rcp_f32 v227, v227
    v_mfma_f32_16x16x32_bf16 v[76:79], a[124:127], v[156:159], v[76:79]
    v_mul_f32 v32, v32, v220
    v_mul_f32 v33, v33, v221
    v_mfma_f32_16x16x32_bf16 v[64:67], a[96:99], v[152:155], v[64:67]
    v_mul_f32 v34, v34, v222
    v_mul_f32 v35, v35, v223
    v_mfma_f32_16x16x32_bf16 v[64:67], a[112:115], v[156:159], v[64:67]
    v_mul_f32 v36, v36, v224
    v_mul_f32 v37, v37, v225
    v_mfma_f32_16x16x32_bf16 v[68:71], a[100:103], v[152:155], v[68:71]
    v_mul_f32 v38, v38, v226
    v_mul_f32 v39, v39, v227
    v_mfma_f32_16x16x32_bf16 v[68:71], a[116:119], v[156:159], v[68:71]
    s_waitcnt vmcnt(8)
    v_mfma_f32_16x16x32_bf16 v[72:75], a[136:139], v[160:163], v[72:75]
    v_mfma_f32_16x16x32_bf16 v[72:75], a[152:155], v[164:167], v[72:75]
    v_mfma_f32_16x16x32_bf16 v[76:79], a[140:143], v[160:163], v[76:79]
    v_mfma_f32_16x16x32_bf16 v[76:79], a[156:159], v[164:167], v[76:79]
    v_mfma_f32_16x16x32_bf16 v[64:67], a[128:131], v[160:163], v[64:67]
    v_mfma_f32_16x16x32_bf16 v[64:67], a[144:147], v[164:167], v[64:67]
    v_mfma_f32_16x16x32_bf16 v[68:71], a[132:135], v[160:163], v[68:71]
    v_mfma_f32_16x16x32_bf16 v[68:71], a[148:151], v[164:167], v[68:71]
    s_nop 1
    ds_write_b128 v18, v[72:75] offset:18432
    s_nop 0
    ds_write_b128 v18, v[76:79] offset:19456
    s_nop 0
    v_pk_add_f32 v[64:65], v[64:65], v[48:49]
    v_pk_add_f32 v[66:67], v[66:67], v[50:51]
    v_pk_add_f32 v[68:69], v[68:69], v[52:53]
k_pad8:
    s_cbranch_execz k_padret
    s_nop 0
    v_pk_add_f32 v[70:71], v[70:71], v[54:55]
    s_waitcnt lgkmcnt(0)
    s_barrier
    ds_read_b128 v[228:231], v20 offset:18432
    ds_read_b128 v[232:235], v20 offset:19456
    s_waitcnt vmcnt(0)
    v_mfma_f32_16x16x32_bf16 v[96:99], v[168:171], v[204:207], 0
    v_mfma_f32_16x16x32_bf16 v[96:99], v[176:179], v[208:211], v[96:99]
    v_mfma_f32_16x16x32_bf16 v[100:103], v[172:175], v[204:207], 0
    v_mfma_f32_16x16x32_bf16 v[100:103], v[180:183], v[208:211], v[100:103]
    v_mfma_f32_16x16x32_bf16 v[104:107], v[168:171], v[212:215], 0
    v_mfma_f32_16x16x32_bf16 v[104:107], v[176:179], v[216:219], v[104:107]
    v_mfma_f32_16x16x32_bf16 v[108:111], v[172:175], v[212:215], 0
    v_mfma_f32_16x16x32_bf16 v[108:111], v[180:183], v[216:219], v[108:111]
    s_waitcnt lgkmcnt(0)
    v_pk_add_f32 v[64:65], v[64:65], v[228:229]
    v_pk_add_f32 v[66:67], v[66:67], v[230:231]
    v_pk_add_f32 v[68:69], v[68:69], v[232:233]
    v_pk_add_f32 v[70:71], v[70:71], v[234:235]
    v_pk_fma_f32 v[184:185], v[32:33], v[96:97], v[184:185]
    v_pk_fma_f32 v[186:187], v[34:35], v[98:99], v[186:187]
    v_pk_fma_f32 v[188:189], v[36:37], v[100:101], v[188:189]
    v_pk_fma_f32 v[190:191], v[38:39], v[102:103], v[190:191]
    v_cvt_pk_bf16_f32 v196, v184, v185
    v_cvt_pk_bf16_f32 v198, v188, v189
    v_cvt_pk_bf16_f32 v197, v186, v187
    v_cvt_pk_bf16_f32 v199, v190, v191
    v_permlane16_swap_b32 v196, v198
    s_nop 0
    v_permlane16_swap_b32 v197, v199
    buffer_store_dwordx4 v[196:199], v12, s[28:31], s48 offen sc1
    v_pk_mul_f32 v[220:221], v[64:65], s[52:53]
    v_pk_mul_f32 v[222:223], v[66:67], s[52:53]
    v_pk_mul_f32 v[224:225], v[68:69], s[52:53]
    v_pk_mul_f32 v[226:227], v[70:71], s[52:53]
    v_exp_f32 v220, v220
    v_exp_f32 v221, v221
    v_exp_f32 v222, v222
    v_exp_f32 v223, v223
    v_exp_f32 v224, v224
    v_exp_f32 v225, v225
    v_exp_f32 v226, v226
    v_exp_f32 v227, v227
    v_pk_add_f32 v[220:221], v[220:221], 1.0 op_sel_hi:[1,0]
    v_pk_add_f32 v[222:223], v[222:223], 1.0 op_sel_hi:[1,0]
    v_pk_add_f32 v[224:225], v[224:225], 1.0 op_sel_hi:[1,0]
    v_pk_add_f32 v[226:227], v[226:227], 1.0 op_sel_hi:[1,0]
    v_rcp_f32 v220, v220
    v_rcp_f32 v221, v221
    v_rcp_f32 v222, v222
    v_rcp_f32 v223, v223
    v_rcp_f32 v224, v224
    v_rcp_f32 v225, v225
    v_rcp_f32 v226, v226
    v_rcp_f32 v227, v227
    v_pk_mul_f32 v[64:65], v[64:65], v[220:221]
    v_pk_mul_f32 v[66:67], v[66:67], v[222:223]
    v_pk_mul_f32 v[68:69], v[68:69], v[224:225]
    v_pk_mul_f32 v[70:71], v[70:71], v[226:227]
    v_pk_fma_f32 v[244:245], v[64:65], v[104:105], v[244:245]
    v_pk_fma_f32 v[246:247], v[66:67], v[106:107], v[246:247]
    v_pk_fma_f32 v[248:249], v[68:69], v[108:109], v[248:249]
    v_pk_fma_f32 v[250:251], v[70:71], v[110:111], v[250:251]
    v_cvt_pk_bf16_f32 v200, v244, v245
    v_cvt_pk_bf16_f32 v202, v248, v249
    v_cvt_pk_bf16_f32 v201, v246, v247
    v_cvt_pk_bf16_f32 v203, v250, v251
    v_permlane16_swap_b32 v200, v202
    s_nop 0
    v_permlane16_swap_b32 v201, v203
    buffer_store_dwordx4 v[200:203], v12, s[28:31], s39 offen sc1
k_end:
    s_endpgm
k_dft:
k_pad1:
    s_cbranch_execz k_padback
    s_nop 0
    s_waitcnt lgkmcnt(1)
    v_mfma_f32_16x16x32_bf16 v[32:35], a[64:67], a[96:99], 0
    ds_read_b128 a[72:75], v16 offset:1024
    v_lshrrev_b32 v29, 4, v0
    v_mfma_f32_16x16x32_bf16 v[36:39], a[64:67], a[100:103], 0
    ds_read_b128 a[76:79], v16 offset:9216
    v_and_b32 v28, 240, v26
    v_mfma_f32_16x16x32_bf16 v[40:43], a[64:67], a[104:107], 0
    v_lshl_add_u32 v29, v29, 2, v28
    v_lshl_add_u32 v28, v1, 8, v29
    v_mfma_f32_16x16x32_bf16 v[44:47], a[64:67], a[108:111], 0
    ds_read_b128 a[80:83], v16 offset:2048
    s_lshl4_add_u32 s61, s37, s40
    v_mfma_f32_16x16x32_bf16 v[196:199], v[192:195], a[96:99], 0
    ds_read_b128 a[84:87], v16 offset:10240
    s_lshl_b32 s61, s61, 8
    v_mfma_f32_16x16x32_bf16 v[200:203], v[192:195], a[100:103], 0
    ds_read_b128 a[88:91], v16 offset:3072
    s_add_u32 s61, s61, 9699328
    v_mfma_f32_16x16x32_bf16 v[204:207], v[192:195], a[104:107], 0
    s_bfe_u32 s4, s2, 131077
    s_lshl_b32 s4, s4, 27
    s_add_u32 s61, s61, s4
    v_mfma_f32_16x16x32_bf16 v[208:211], v[192:195], a[108:111], 0
    ds_read_b128 a[92:95], v16 offset:11264
    s_waitcnt lgkmcnt(6)
    v_mfma_f32_16x16x32_bf16 v[60:63], a[68:71], a[108:111], 0
    ds_read_b128 a[112:115], v17 offset:0
    s_mov_b32 s4, 0xffff0000
    v_mfma_f32_16x16x32_bf16 v[56:59], a[68:71], a[104:107], 0
    ds_read_b128 a[116:119], v17 offset:8192
    s_mov_b32 s5, 0xffff0000
    v_mfma_f32_16x16x32_bf16 v[52:55], a[68:71], a[100:103], 0
    s_mov_b32 s6, 0
    s_mov_b32 s7, -1
    s_mov_b32 s62, 9666560
    v_mfma_f32_16x16x32_bf16 v[48:51], a[68:71], a[96:99], 0
    ds_read_b128 a[120:123], v17 offset:1024
    s_waitcnt lgkmcnt(7)
    v_mfma_f32_16x16x32_bf16 v[64:67], a[72:75], a[96:99], 0
    ds_read_b128 a[124:127], v17 offset:9216
    s_and_b32 s47, s36, 1
    v_mfma_f32_16x16x32_bf16 v[68:71], a[72:75], a[100:103], 0
    ds_read_b128 a[128:131], v17 offset:2048
    s_lshl_b32 s47, s47, 6
    v_mfma_f32_16x16x32_bf16 v[72:75], a[72:75], a[104:107], 0
    buffer_load_dwordx4 v12, s[8:11], s45 offen offset:2048 lds
    v_mfma_f32_16x16x32_bf16 v[76:79], a[72:75], a[108:111], 0
    ds_read_b128 a[132:135], v17 offset:10240
    s_add_u32 s47, s47, 64
    v_mfma_f32_16x16x32_bf16 v[92:95], a[76:79], a[108:111], 0
    ds_read_b128 a[136:139], v17 offset:3072
    s_mov_b32 s60, s38
    v_mfma_f32_16x16x32_bf16 v[88:91], a[76:79], a[104:107], 0
    ds_read_b128 a[140:143], v17 offset:11264
    v_add_u32 v6, 131072, v26
    v_mfma_f32_16x16x32_bf16 v[84:87], a[76:79], a[100:103], 0
    buffer_load_dwordx4 v13, s[8:11], s45 offen offset:3072 lds
    v_mfma_f32_16x16x32_bf16 v[80:83], a[76:79], a[96:99], 0
    s_add_u32 m0, s43, 32768
    s_waitcnt lgkmcnt(10)
    s_and_b32 s51, s2, 6
    v_mfma_f32_16x16x32_bf16 v[96:99], a[80:83], a[96:99], 0
    ds_read_b128 a[160:163], v6 offset:0
    s_xor_b32 s44, s40, 2
    v_mfma_f32_16x16x32_bf16 v[100:103], a[80:83], a[100:103], 0
    ds_read_b128 a[164:167], v6 offset:1024
    s_mul_i32 s44, s44, s42
    v_mfma_f32_16x16x32_bf16 v[104:107], a[80:83], a[104:107], 0
    buffer_load_dwordx4 v8, s[12:15], s44 offen offset:0 lds
    v_mfma_f32_16x16x32_bf16 v[108:111], a[80:83], a[108:111], 0
    ds_read_b128 a[168:171], v6 offset:2048
    s_bfe_u32 s52, s2, 0x10004
    v_mfma_f32_16x16x32_bf16 v[124:127], a[84:87], a[108:111], 0
    ds_read_b128 a[172:175], v6 offset:3072
    s_add_u32 s51, s51, s52
    v_mfma_f32_16x16x32_bf16 v[120:123], a[84:87], a[104:107], 0
    ds_read_b128 a[176:179], v6 offset:4096
    s_and_b32 s52, s2, 1
    v_mfma_f32_16x16x32_bf16 v[116:119], a[84:87], a[100:103], 0
    buffer_load_dwordx4 v8, s[16:19], s44 offen offset:1024 lds
    v_mfma_f32_16x16x32_bf16 v[112:115], a[84:87], a[96:99], 0
    ds_read_b128 a[180:183], v6 offset:5120
    s_waitcnt lgkmcnt(14)
    v_mfma_f32_16x16x32_bf16 v[128:131], a[88:91], a[96:99], 0
    ds_read_b128 a[184:187], v6 offset:6144
    s_lshl1_add_u32 s51, s51, s52
    v_mfma_f32_16x16x32_bf16 v[132:135], a[88:91], a[100:103], 0
    ds_read_b128 a[188:191], v6 offset:7168
    s_sub_u32 s52, 16, s51
    v_mfma_f32_16x16x32_bf16 v[136:139], a[88:91], a[104:107], 0
    buffer_load_dwordx4 v9, s[12:15], s44 offen offset:2048 lds
    v_mfma_f32_16x16x32_bf16 v[140:143], a[88:91], a[108:111], 0
    ds_read_b128 a[192:195], v6 offset:8192
    s_and_b32 s52, s52, 15
    v_mfma_f32_16x16x32_bf16 v[156:159], a[92:95], a[108:111], 0
    ds_read_b128 a[196:199], v6 offset:9216
    s_add_u32 s52, s52, 16
    v_mfma_f32_16x16x32_bf16 v[152:155], a[92:95], a[104:107], 0
    ds_read_b128 a[200:203], v6 offset:10240
    s_sub_u32 s52, s52, s51
    v_mfma_f32_16x16x32_bf16 v[148:151], a[92:95], a[100:103], 0
    buffer_load_dwordx4 v9, s[16:19], s44 offen offset:3072 lds
    v_mfma_f32_16x16x32_bf16 v[144:147], a[92:95], a[96:99], 0
    s_waitcnt vmcnt(10) lgkmcnt(15)
    s_barrier
    ds_read_b64_tr_b16 a[144:145], v14 offset:16384
    ds_read_b64_tr_b16 a[146:147], v14 offset:20480
    ds_read_b64_tr_b16 a[148:149], v15 offset:16384
    ds_read_b64_tr_b16 a[150:151], v15 offset:20480
    ds_read_b64_tr_b16 a[152:153], v14 offset:17408
    ds_read_b64_tr_b16 a[154:155], v14 offset:21504
    ds_read_b64_tr_b16 a[156:157], v15 offset:17408
    ds_read_b64_tr_b16 a[158:159], v15 offset:21504
    s_add_u32 m0, s43, 49152
    s_xor_b32 s44, s40, 3
    s_mul_i32 s44, s44, s42
    buffer_load_dwordx4 v8, s[12:15], s44 offen offset:0 lds
    s_mov_b32 s96, 0xbf803f80
    s_waitcnt vmcnt(9)
    s_nop 0
    v_dot2_f32_bf16 v168, v160, v192, 0
    v_dot2_f32_bf16 v169, v160, s96, 0
    v_dot2_f32_bf16 v168, v161, v192, v168
    v_dot2_f32_bf16 v169, v161, s96, v169
    v_dot2_f32_bf16 v168, v162, v192, v168
    v_dot2_f32_bf16 v169, v162, s96, v169
    v_dot2_f32_bf16 v168, v163, v192, v168
    v_dot2_f32_bf16 v169, v163, s96, v169
    buffer_load_dwordx4 v8, s[16:19], s44 offen offset:1024 lds
    v_dot2_f32_bf16 v168, v164, v192, v168
    v_dot2_f32_bf16 v169, v164, s96, v169
    v_dot2_f32_bf16 v168, v165, v192, v168
    v_dot2_f32_bf16 v169, v165, s96, v169
    v_dot2_f32_bf16 v168, v166, v192, v168
    v_dot2_f32_bf16 v169, v166, s96, v169
    v_dot2_f32_bf16 v168, v167, v192, v168
    v_dot2_f32_bf16 v169, v167, s96, v169
    buffer_load_dwordx4 v9, s[12:15], s44 offen offset:2048 lds
    s_waitcnt lgkmcnt(0)
    v_mfma_f32_16x16x32_bf16 v[32:35], a[112:115], a[144:147], v[32:35]
    s_movk_i32 s97, 0x3f80
    s_mov_b32 s98, 1.0
    s_bfe_u32 s49, s2, 65543
    v_mfma_f32_16x16x32_bf16 v[36:39], a[112:115], a[148:151], v[36:39]
    s_mul_i32 s52, s52, s49
    v_add_f32_dpp v168, v168, v168 quad_perm:[1,0,3,2] row_mask:0xf bank_mask:0xf
    v_add_f32_dpp v169, v169, v169 quad_perm:[1,0,3,2] row_mask:0xf bank_mask:0xf
    v_mfma_f32_16x16x32_bf16 v[40:43], a[112:115], a[152:155], v[40:43]
    s_add_u32 s49, s51, s52
    v_add_f32_dpp v168, v168, v168 quad_perm:[2,3,0,1] row_mask:0xf bank_mask:0xf
    v_add_f32_dpp v169, v169, v169 quad_perm:[2,3,0,1] row_mask:0xf bank_mask:0xf
    v_mfma_f32_16x16x32_bf16 v[44:47], a[112:115], a[156:159], v[44:47]
    s_bfe_u32 s51, s2, 0x20005
    v_add_f32_dpp v168, v168, v168 row_half_mirror row_mask:0xf bank_mask:0xf
    v_add_f32_dpp v169, v169, v169 row_half_mirror row_mask:0xf bank_mask:0xf
    v_mfma_f32_16x16x32_bf16 v[196:199], v[192:195], a[144:147], v[196:199]
    s_bfe_u32 s52, s2, 0x10003
    v_add_f32_dpp v168, v168, v168 row_mirror row_mask:0xf bank_mask:0xf
    v_add_f32_dpp v169, v169, v169 row_mirror row_mask:0xf bank_mask:0xf
    v_mfma_f32_16x16x32_bf16 v[200:203], v[192:195], a[148:151], v[200:203]
    s_lshl1_add_u32 s50, s51, s52
    v_mov_b32 v172, v168
    v_mov_b32 v173, v169
    v_mfma_f32_16x16x32_bf16 v[204:207], v[192:195], a[152:155], v[204:207]
    s_xor_b32 s50, s50, 1
    v_permlane16_swap_b32 v168, v172
    v_mfma_f32_16x16x32_bf16 v[208:211], v[192:195], a[156:159], v[208:211]
    s_and_b32 s51, s50, 7
    v_permlane16_swap_b32 v169, v173
    v_mfma_f32_16x16x32_bf16 v[60:63], a[116:119], a[156:159], v[60:63]
    s_mul_i32 s51, s51, 0
    v_add_f32 v168, v168, v172
    v_add_f32_e64 v169, v169, v173
    v_mfma_f32_16x16x32_bf16 v[56:59], a[116:119], a[152:155], v[56:59]
    ds_read_b128 a[204:207], v6 offset:11264
    v_mul_f32 v168, 0xbb000000, v168
    v_mfma_f32_16x16x32_bf16 v[52:55], a[116:119], a[148:151], v[52:55]
    buffer_load_dwordx4 v9, s[16:19], s44 offen offset:3072 lds
    v_mfma_f32_16x16x32_bf16 v[48:51], a[116:119], a[144:147], v[48:51]
    ds_read_b128 a[208:211], v6 offset:12288
    s_lshr_b32 s51, s51, 258
    v_mfma_f32_16x16x32_bf16 v[64:67], a[120:123], a[144:147], v[64:67]
    ds_read_b128 a[212:215], v6 offset:13312
    s_add_u32 m0, s43, 98304
    v_mfma_f32_16x16x32_bf16 v[68:71], a[120:123], a[148:151], v[68:71]
    ds_read_b128 a[216:219], v6 offset:14336
    s_xor_b32 s45, s41, 256
    v_mfma_f32_16x16x32_bf16 v[72:75], a[120:123], a[152:155], v[72:75]
    buffer_load_dwordx4 v10, s[8:11], s45 offen offset:0 lds
    v_mfma_f32_16x16x32_bf16 v[76:79], a[120:123], a[156:159], v[76:79]
    ds_read_b128 a[220:223], v6 offset:15360
    s_lshl_b32 s51, s51, 10
    v_mfma_f32_16x16x32_bf16 v[92:95], a[124:127], a[156:159], v[92:95]
    s_and_b32 s56, s38, 1
    s_and_b32 s57, s37, 1
    s_lshl1_add_u32 s57, s56, s57
    v_mfma_f32_16x16x32_bf16 v[88:91], a[124:127], a[152:155], v[88:91]
    s_lshl_b32 s57, s57, 267
    s_or_b32 s56, s56, s36
    s_min_u32 s56, s56, 1
    v_mfma_f32_16x16x32_bf16 v[84:87], a[124:127], a[148:151], v[84:87]
    buffer_load_dwordx4 v11, s[8:11], s45 offen offset:1024 lds
    v_mfma_f32_16x16x32_bf16 v[80:83], a[124:127], a[144:147], v[80:83]
    s_bfe_u32 s52, s2, 0x10004
    v_add_u32_e64 v6, s57, v6
    v_lshl_add_u32 v7, s56, 10, v6
    v_mfma_f32_16x16x32_bf16 v[96:99], a[128:131], a[144:147], v[96:99]
    ds_read_b128 a[224:227], v6
    s_lshr_b32 s64, s2, 263
    v_mfma_f32_16x16x32_bf16 v[100:103], a[128:131], a[148:151], v[100:103]
    ds_read_b128 a[228:231], v7
    s_lshl1_add_u32 s52, s52, s64
    v_mfma_f32_16x16x32_bf16 v[104:107], a[128:131], a[152:155], v[104:107]
    buffer_load_dwordx4 v12, s[8:11], s45 offen offset:2048 lds
    v_mfma_f32_16x16x32_bf16 v[108:111], a[128:131], a[156:159], v[108:111]
    s_and_b32 s52, s52, 2
    v_xor_b32 v6, 12288, v6
    v_xor_b32 v7, 12288, v7
    v_mfma_f32_16x16x32_bf16 v[124:127], a[132:135], a[156:159], v[124:127]
    ds_read_b128 a[232:235], v6
    s_mul_i32 s52, s52, 7
    v_mfma_f32_16x16x32_bf16 v[120:123], a[132:135], a[152:155], v[120:123]
    ds_read_b128 a[236:239], v7
    s_lshr_b32 s52, s52, 1
    v_mfma_f32_16x16x32_bf16 v[116:119], a[132:135], a[148:151], v[116:119]
    buffer_load_dwordx4 v13, s[8:11], s45 offen offset:3072 lds
    v_mfma_f32_16x16x32_bf16 v[112:115], a[132:135], a[144:147], v[112:115]
    s_add_u32 m0, s43, 0
    s_min_u32 s57, s36, 1
    s_lshl_b32 s57, s57, 10
    v_mfma_f32_16x16x32_bf16 v[128:131], a[136:139], a[144:147], v[128:131]
    s_xor_b32 s44, s40, 4
    s_add_u32 s57, s57, 131072
    v_add_u32 v7, s57, v26
    v_mfma_f32_16x16x32_bf16 v[132:135], a[136:139], a[148:151], v[132:135]
    s_mul_i32 s44, s44, s42
    s_lshl_b32 s52, s52, 266
    v_xor_b32 v6, 1024, v7
    v_mfma_f32_16x16x32_bf16 v[136:139], a[136:139], a[152:155], v[136:139]
    buffer_load_dwordx4 v8, s[12:15], s44 offen offset:0 lds
    v_mfma_f32_16x16x32_bf16 v[140:143], a[136:139], a[156:159], v[140:143]
    ds_read_b128 a[240:243], v6 offset:0
    s_add_u32 s51, s51, s52
    v_mfma_f32_16x16x32_bf16 v[156:159], a[140:143], a[156:159], v[156:159]
    ds_read_b128 a[244:247], v7 offset:0
    s_sub_u32 s52, s51, 14336
    v_mfma_f32_16x16x32_bf16 v[152:155], a[140:143], a[152:155], v[152:155]
    ds_read_b128 a[248:251], v6 offset:2048
    s_min_u32 s64, s51, s52
    v_mfma_f32_16x16x32_bf16 v[148:151], a[140:143], a[148:151], v[148:151]
    buffer_load_dwordx4 v8, s[16:19], s44 offen offset:1024 lds
    v_mfma_f32_16x16x32_bf16 v[144:147], a[140:143], a[144:147], v[144:147]
    v_dot2_f32_bf16 v176, v160, s97, v168
    v_dot2_f32_bf16 v160, v160, s98, v168
    v_dot2_f32_bf16 v177, v161, s97, v168
    v_dot2_f32_bf16 v161, v161, s98, v168
    v_dot2_f32_bf16 v178, v162, s97, v168
    v_dot2_f32_bf16 v162, v162, s98, v168
    v_dot2_f32_bf16 v179, v163, s97, v168
    v_dot2_f32_bf16 v163, v163, s98, v168
    v_dot2_f32_bf16 v180, v164, s97, v168
    v_dot2_f32_bf16 v164, v164, s98, v168
    v_dot2_f32_bf16 v181, v165, s97, v168
    v_dot2_f32_bf16 v165, v165, s98, v168
    buffer_load_dwordx4 v9, s[12:15], s44 offen offset:2048 lds
    v_dot2_f32_bf16 v182, v166, s97, v168
    v_dot2_f32_bf16 v166, v166, s98, v168
    v_dot2_f32_bf16 v183, v167, s97, v168
    v_dot2_f32_bf16 v167, v167, s98, v168
    v_pk_mul_f32 v[170:171], v[176:177], v[176:177]
    v_pk_fma_f32 v[170:171], v[160:161], v[160:161], v[170:171]
    v_pk_fma_f32 v[170:171], v[178:179], v[178:179], v[170:171]
    v_pk_fma_f32 v[170:171], v[162:163], v[162:163], v[170:171]
    v_pk_fma_f32 v[170:171], v[180:181], v[180:181], v[170:171]
    v_pk_fma_f32 v[170:171], v[164:165], v[164:165], v[170:171]
    v_pk_fma_f32 v[170:171], v[182:183], v[182:183], v[170:171]
    v_pk_fma_f32 v[170:171], v[166:167], v[166:167], v[170:171]
    v_add_f32_e64 v170, v170, v171
    s_waitcnt vmcnt(11) lgkmcnt(12)
    s_barrier
    ds_read_b64_tr_b16 a[96:97], v14 offset:32768
    ds_read_b64_tr_b16 a[98:99], v14 offset:36864
    ds_read_b64_tr_b16 a[100:101], v15 offset:32768
    ds_read_b64_tr_b16 a[102:103], v15 offset:36864
    ds_read_b64_tr_b16 a[104:105], v14 offset:33792
    ds_read_b64_tr_b16 a[106:107], v14 offset:37888
    ds_read_b64_tr_b16 a[108:109], v15 offset:33792
    ds_read_b64_tr_b16 a[110:111], v15 offset:37888
    ds_read_b128 a[64:67], v16 offset:16384
    ds_read_b128 a[68:71], v16 offset:24576
    buffer_load_dwordx4 v9, s[16:19], s44 offen offset:3072 lds
    s_waitcnt lgkmcnt(1)
    v_mfma_f32_16x16x32_bf16 v[32:35], a[64:67], a[96:99], v[32:35]
    s_add_u32 m0, s43, 16384
    s_xor_b32 s44, s40, 5
    v_add_f32_dpp v170, v170, v170 quad_perm:[1,0,3,2] row_mask:0xf bank_mask:0xf
    v_mfma_f32_16x16x32_bf16 v[36:39], a[64:67], a[100:103], v[36:39]
    ds_read_b128 a[72:75], v16 offset:17408
    s_mul_i32 s44, s44, s42
    v_mfma_f32_16x16x32_bf16 v[40:43], a[64:67], a[104:107], v[40:43]
    buffer_load_dwordx4 v8, s[12:15], s44 offen offset:0 lds
    v_mfma_f32_16x16x32_bf16 v[44:47], a[64:67], a[108:111], v[44:47]
    ds_read_b128 a[76:79], v16 offset:25600
    v_add_f32_dpp v170, v170, v170 quad_perm:[2,3,0,1] row_mask:0xf bank_mask:0xf
    v_mfma_f32_16x16x32_bf16 v[196:199], v[192:195], a[96:99], v[196:199]
    ds_read_b128 a[80:83], v16 offset:18432
    s_mov_b32 s30, 2097152
    v_mfma_f32_16x16x32_bf16 v[200:203], v[192:195], a[100:103], v[200:203]
    ds_read_b128 a[84:87], v16 offset:26624
    v_add_f32_dpp v170, v170, v170 row_half_mirror row_mask:0xf bank_mask:0xf
    v_mfma_f32_16x16x32_bf16 v[204:207], v[192:195], a[104:107], v[204:207]
    buffer_load_dwordx4 v8, s[16:19], s44 offen offset:1024 lds
    v_mfma_f32_16x16x32_bf16 v[208:211], v[192:195], a[108:111], v[208:211]
    ds_read_b128 a[88:91], v16 offset:19456
    s_waitcnt lgkmcnt(5)
    v_mfma_f32_16x16x32_bf16 v[60:63], a[68:71], a[108:111], v[60:63]
    ds_read_b128 a[92:95], v16 offset:27648
    v_add_f32_dpp v170, v170, v170 row_mirror row_mask:0xf bank_mask:0xf
    v_mfma_f32_16x16x32_bf16 v[56:59], a[68:71], a[104:107], v[56:59]
    ds_read_b128 a[112:115], v17 offset:16384
    s_mov_b32 s31, s11
    v_mfma_f32_16x16x32_bf16 v[52:55], a[68:71], a[100:103], v[52:55]
    buffer_load_dwordx4 v9, s[12:15], s44 offen offset:2048 lds
    v_mfma_f32_16x16x32_bf16 v[48:51], a[68:71], a[96:99], v[48:51]
    s_waitcnt lgkmcnt(5)
    s_waitcnt vmcnt(11) lgkmcnt(1)
    s_barrier
    s_load_dword s96, s[32:33], 0
    v_mfma_f32_16x16x32_bf16 v[64:67], a[72:75], a[96:99], v[64:67]
    ds_read_b128 a[116:119], v17 offset:24576
    ds_read_b64_tr_b16 a[144:145], v14 offset:49152
    v_mfma_f32_16x16x32_bf16 v[68:71], a[72:75], a[100:103], v[68:71]
    ds_read_b128 a[120:123], v17 offset:17408
    ds_read_b64_tr_b16 a[146:147], v14 offset:53248
    v_mfma_f32_16x16x32_bf16 v[72:75], a[72:75], a[104:107], v[72:75]
    buffer_load_dwordx4 v9, s[16:19], s44 offen offset:3072 lds
    v_mfma_f32_16x16x32_bf16 v[76:79], a[72:75], a[108:111], v[76:79]
    ds_read_b128 a[124:127], v17 offset:25600
    ds_read_b64_tr_b16 a[148:149], v15 offset:49152
    v_mfma_f32_16x16x32_bf16 v[92:95], a[76:79], a[108:111], v[92:95]
    ds_read_b128 a[128:131], v17 offset:18432
    s_add_u32 m0, s43, 65536
    v_mfma_f32_16x16x32_bf16 v[88:91], a[76:79], a[104:107], v[88:91]
    ds_read_b128 a[132:135], v17 offset:26624
    s_xor_b32 s45, s41, 384
    v_mfma_f32_16x16x32_bf16 v[84:87], a[76:79], a[100:103], v[84:87]
    buffer_load_dwordx4 v10, s[8:11], s45 offen offset:0 lds
    v_mfma_f32_16x16x32_bf16 v[80:83], a[76:79], a[96:99], v[80:83]
    ds_read_b128 a[136:139], v17 offset:19456
    s_waitcnt lgkmcnt(12)
    v_mfma_f32_16x16x32_bf16 v[96:99], a[80:83], a[96:99], v[96:99]
    ds_read_b128 a[140:143], v17 offset:27648
    ds_read_b64_tr_b16 a[150:151], v15 offset:53248
    v_mfma_f32_16x16x32_bf16 v[100:103], a[80:83], a[100:103], v[100:103]
    ds_read_b64_tr_b16 a[152:153], v14 offset:50176
    v_mov_b32 v172, v170
    v_mfma_f32_16x16x32_bf16 v[104:107], a[80:83], a[104:107], v[104:107]
    buffer_load_dwordx4 v11, s[8:11], s45 offen offset:1024 lds
    v_mfma_f32_16x16x32_bf16 v[108:111], a[80:83], a[108:111], v[108:111]
    ds_read_b64_tr_b16 a[154:155], v14 offset:54272
    v_permlane16_swap_b32_e64 v170, v172
    v_mfma_f32_16x16x32_bf16 v[124:127], a[84:87], a[108:111], v[124:127]
    ds_read_b64_tr_b16 a[156:157], v15 offset:50176
    s_mul_i32 s52, s38, 458752
    v_mfma_f32_16x16x32_bf16 v[120:123], a[84:87], a[104:107], v[120:123]
    ds_read_b64_tr_b16 a[158:159], v15 offset:54272
    v_add_f32_e64 v170, v170, v172
    v_mfma_f32_16x16x32_bf16 v[116:119], a[84:87], a[100:103], v[116:119]
    buffer_load_dwordx4 v12, s[8:11], s45 offen offset:2048 lds
    v_mfma_f32_16x16x32_bf16 v[112:115], a[84:87], a[96:99], v[112:115]
    s_waitcnt lgkmcnt(15)
    v_mul_f32 v170, 0x3b000000, v170
    v_cvt_pk_bf16_f32 v170, 0, v170
    v_mfma_f32_16x16x32_bf16 v[128:131], a[88:91], a[96:99], v[128:131]
    s_lshl_b32 s51, s50, 7
    v_add_f32 v170, 0x3727c5ac, v170
    v_cvt_pk_bf16_f32 v170, 0, v170
    v_mfma_f32_16x16x32_bf16 v[132:135], a[88:91], a[100:103], v[132:135]
    s_add_u32 s51, s51, s52
    v_sqrt_f32 v170, v170
    v_mfma_f32_16x16x32_bf16 v[136:139], a[88:91], a[104:107], v[136:139]
    buffer_load_dwordx4 v13, s[8:11], s45 offen offset:3072 lds
    v_mfma_f32_16x16x32_bf16 v[140:143], a[88:91], a[108:111], v[140:143]
    s_add_u32 m0, s43, 32768
    v_cvt_pk_bf16_f32 v172, 0, v168
    v_cvt_pk_bf16_f32 v170, 0, v170
    v_mfma_f32_16x16x32_bf16 v[156:159], a[92:95], a[108:111], v[156:159]
    s_xor_b32 s44, s40, 6
    v_rcp_f32 v175, v170
    v_mfma_f32_16x16x32_bf16 v[152:155], a[92:95], a[104:107], v[152:155]
    s_mul_i32 s44, s44, s42
    v_mul_f32 v173, v170, v170
    v_mul_f32 v174, 0xbfb8aa3b, v175
    v_mfma_f32_16x16x32_bf16 v[148:151], a[92:95], a[100:103], v[148:151]
    buffer_load_dwordx4 v8, s[12:15], s44 offen offset:0 lds
    v_mfma_f32_16x16x32_bf16 v[144:147], a[92:95], a[96:99], v[144:147]
    s_waitcnt vmcnt(9) lgkmcnt(0)
    s_barrier
    v_mfma_f32_16x16x32_bf16 v[32:35], a[112:115], a[144:147], v[32:35]
    ds_read_b64_tr_b16 a[96:97], v14 offset:0
    v_mul_f32_e64 v175, v169, v175
    v_mfma_f32_16x16x32_bf16 v[36:39], a[112:115], a[148:151], v[36:39]
    ds_read_b128 a[64:67], v16 offset:32768
    s_cmp_lt_i32 s96, 8
    s_cbranch_scc1 drdy_slow
drdy_back:
    v_mfma_f32_16x16x32_bf16 v[40:43], a[112:115], a[152:155], v[40:43]
    buffer_load_dwordx4 v8, s[16:19], s44 offen offset:1024 lds
    v_mfma_f32_16x16x32_bf16 v[44:47], a[112:115], a[156:159], v[44:47]
    ds_read_b64_tr_b16 a[98:99], v14 offset:4096
    v_lshrrev_b32_e64 v2, 3, v0
    v_mfma_f32_16x16x32_bf16 v[196:199], v[192:195], a[144:147], v[196:199]
    ds_read_b128 a[68:71], v16 offset:40960
    v_lshrrev_b32_e64 v3, 4, v0
    v_mfma_f32_16x16x32_bf16 v[200:203], v[192:195], a[148:151], v[200:203]
    ds_read_b64_tr_b16 a[100:101], v15 offset:0
    v_lshlrev_b32_e64 v3, 1, v3
    v_mfma_f32_16x16x32_bf16 v[204:207], v[192:195], a[152:155], v[204:207]
    buffer_load_dwordx4 v9, s[12:15], s44 offen offset:2048 lds
    v_mfma_f32_16x16x32_bf16 v[208:211], v[192:195], a[156:159], v[208:211]
    ds_read_b128 a[72:75], v16 offset:33792
    v_and_b32_e64 v4, 7, v0
    v_mfma_f32_16x16x32_bf16 v[60:63], a[116:119], a[156:159], v[60:63]
    ds_read_b64_tr_b16 a[102:103], v15 offset:4096
    v_xor_b32_e64 v3, v3, v4
    v_mfma_f32_16x16x32_bf16 v[56:59], a[116:119], a[152:155], v[56:59]
    ds_read_b128 a[76:79], v16 offset:41984
    v_lshl_add_u32 v3, v3, 4, s51
    v_mfma_f32_16x16x32_bf16 v[52:55], a[116:119], a[148:151], v[52:55]
    buffer_load_dwordx4 v9, s[16:19], s44 offen offset:3072 lds
    v_mfma_f32_16x16x32_bf16 v[48:51], a[116:119], a[144:147], v[48:51]
    ds_read_b64_tr_b16 a[104:105], v14 offset:1024
    s_add_u32 m0, s43, 49152
    v_mfma_f32_16x16x32_bf16 v[64:67], a[120:123], a[144:147], v[64:67]
    ds_read_b128 a[80:83], v16 offset:34816
    s_xor_b32 s44, s40, 7
    v_mfma_f32_16x16x32_bf16 v[68:71], a[120:123], a[148:151], v[68:71]
    ds_read_b64_tr_b16 a[106:107], v14 offset:5120
    s_mul_i32 s44, s44, s42
    v_mfma_f32_16x16x32_bf16 v[72:75], a[120:123], a[152:155], v[72:75]
    buffer_load_dwordx4 v8, s[12:15], s44 offen offset:0 lds
    v_mfma_f32_16x16x32_bf16 v[76:79], a[120:123], a[156:159], v[76:79]
    ds_read_b128 a[84:87], v16 offset:43008
    v_cndmask_b32 v196, v196, v200, s[4:5]
    v_mfma_f32_16x16x32_bf16 v[92:95], a[124:127], a[156:159], v[92:95]
    ds_read_b64_tr_b16 a[108:109], v15 offset:1024
    v_cndmask_b32 v204, v204, v208, s[4:5]
    v_mfma_f32_16x16x32_bf16 v[88:91], a[124:127], a[152:155], v[88:91]
    ds_read_b128 a[88:91], v16 offset:35840
    v_cndmask_b32 v196, v196, v204, s[6:7]
    v_mfma_f32_16x16x32_bf16 v[84:87], a[124:127], a[148:151], v[84:87]
    buffer_load_dwordx4 v8, s[16:19], s44 offen offset:1024 lds
    v_mfma_f32_16x16x32_bf16 v[80:83], a[124:127], a[144:147], v[80:83]
    ds_read_b64_tr_b16 a[110:111], v15 offset:5120
    v_lshl_add_u32 v18, v2, 10, v3
    v_mfma_f32_16x16x32_bf16 v[96:99], a[128:131], a[144:147], v[96:99]
    ds_read_b128 a[92:95], v16 offset:44032
    v_add_u32 v19, 7168, v18
    v_mfma_f32_16x16x32_bf16 v[100:103], a[128:131], a[148:151], v[100:103]
    buffer_store_dwordx4 v[172:175], v5, s[20:23], s62 offen sc1
    v_mfma_f32_16x16x32_bf16 v[104:107], a[128:131], a[152:155], v[104:107]
    buffer_load_dwordx4 v9, s[12:15], s44 offen offset:2048 lds
    v_mfma_f32_16x16x32_bf16 v[108:111], a[128:131], a[156:159], v[108:111]
    buffer_store_dword v196, v28, s[20:23], s61 offen sc1
    v_mfma_f32_16x16x32_bf16 v[124:127], a[132:135], a[156:159], v[124:127]
    ds_read_b128 a[252:255], v7 offset:2048
    v_add_u32 v20, 14336, v18
    v_mfma_f32_16x16x32_bf16 v[120:123], a[132:135], a[152:155], v[120:123]
    ds_read_b128 v[212:215], v6 offset:12288
    v_add_u32 v21, 21504, v18
    v_mfma_f32_16x16x32_bf16 v[116:119], a[132:135], a[148:151], v[116:119]
    buffer_load_dwordx4 v9, s[16:19], s44 offen offset:3072 lds
    v_mfma_f32_16x16x32_bf16 v[112:115], a[132:135], a[144:147], v[112:115]
    ds_read_b128 v[216:219], v7 offset:12288
    v_bfe_u32 v2, v0, 2, 3
    v_mfma_f32_16x16x32_bf16 v[128:131], a[136:139], a[144:147], v[128:131]
    ds_read_b128 v[244:247], v6 offset:14336
    s_add_u32 m0, s43, 81920
    v_mfma_f32_16x16x32_bf16 v[132:135], a[136:139], a[148:151], v[132:135]
    ds_read_b128 v[248:251], v7 offset:14336
    s_xor_b32 s45, s41, 512
    v_mfma_f32_16x16x32_bf16 v[136:139], a[136:139], a[152:155], v[136:139]
    buffer_load_dwordx4 v10, s[8:11], s45 offen offset:0 lds
    v_mfma_f32_16x16x32_bf16 v[140:143], a[136:139], a[156:159], v[140:143]
    s_lshl_b32 s61, s37, 12
    v_lshrrev_b32 v3, 5, v0
    v_lshlrev_b32_e64 v3, 10, v3
    v_mfma_f32_16x16x32_bf16 v[156:159], a[140:143], a[156:159], v[156:159]
    s_add_u32 s61, s61, 9699328
    v_lshl_add_u32 v3, v2, 7, v3
    v_lshl_add_u32 v3, v1, 12, v3
    v_mfma_f32_16x16x32_bf16 v[152:155], a[140:143], a[152:155], v[152:155]
    s_lshl_b32 s62, s36, 11
    v_and_b32 v4, 3, v0
    v_lshl_add_u32 v3, v4, 3, v3
    v_mfma_f32_16x16x32_bf16 v[148:151], a[140:143], a[148:151], v[148:151]
    buffer_load_dwordx4 v11, s[8:11], s45 offen offset:1024 lds
    v_mfma_f32_16x16x32_bf16 v[144:147], a[140:143], a[144:147], v[144:147]
k_pad9:
    s_cbranch_execz k_padback
    s_nop 0
    s_waitcnt vmcnt(16) lgkmcnt(0)
    s_barrier
    v_mfma_f32_16x16x32_bf16 v[32:35], a[64:67], a[96:99], v[32:35]
    ds_read_b64_tr_b16 a[144:145], v14 offset:16384
    v_lshrrev_b32_e64 v2, 1, v2
    v_mfma_f32_16x16x32_bf16 v[36:39], a[64:67], a[100:103], v[36:39]
    ds_read_b128 a[112:115], v17 offset:32768
    v_and_b32_e64 v4, 2, v1
    v_mfma_f32_16x16x32_bf16 v[40:43], a[64:67], a[104:107], v[40:43]
    s_add_u32 s62, s62, 9666560
    v_xor_b32_e64 v2, v2, v4
    v_lshl_add_u32 v3, v2, 5, v3
    v_mfma_f32_16x16x32_bf16 v[44:47], a[64:67], a[108:111], v[44:47]
    ds_read_b64_tr_b16 a[146:147], v14 offset:20480
    v_add_u32 v22, 98304, v3
    v_mfma_f32_16x16x32_bf16 v[60:63], a[68:71], a[108:111], v[60:63]
    ds_read_b128 a[116:119], v17 offset:40960
    v_xor_b32_e64 v23, 32, v22
    v_mfma_f32_16x16x32_bf16 v[56:59], a[68:71], a[104:107], v[56:59]
    ds_read_b64_tr_b16 a[148:149], v15 offset:16384
    v_xor_b32_e64 v24, 64, v22
    v_mfma_f32_16x16x32_bf16 v[52:55], a[68:71], a[100:103], v[52:55]
    buffer_load_dwordx4 v12, s[8:11], s45 offen offset:2048 lds
    v_mfma_f32_16x16x32_bf16 v[48:51], a[68:71], a[96:99], v[48:51]
    ds_read_b128 a[120:123], v17 offset:33792
    v_xor_b32 v25, 96, v22
    v_mfma_f32_16x16x32_bf16 v[64:67], a[72:75], a[96:99], v[64:67]
    ds_read_b64_tr_b16 a[150:151], v15 offset:20480
    s_lshr_b32 s51, s2, 260
    v_mfma_f32_16x16x32_bf16 v[68:71], a[72:75], a[100:103], v[68:71]
    ds_read_b128 a[124:127], v17 offset:41984
    s_and_b32 s52, s2, 7
    v_mfma_f32_16x16x32_bf16 v[72:75], a[72:75], a[104:107], v[72:75]
    buffer_load_dwordx4 v13, s[8:11], s45 offen offset:3072 lds
    v_mfma_f32_16x16x32_bf16 v[76:79], a[72:75], a[108:111], v[76:79]
    ds_read_b64_tr_b16 a[152:153], v14 offset:17408
    s_add_u32 m0, s43, 0
    v_mfma_f32_16x16x32_bf16 v[92:95], a[76:79], a[108:111], v[92:95]
    ds_read_b128 a[128:131], v17 offset:34816
    s_xor_b32 s44, s40, 8
    v_mfma_f32_16x16x32_bf16 v[88:91], a[76:79], a[104:107], v[88:91]
    ds_read_b64_tr_b16 a[154:155], v14 offset:21504
    s_mul_i32 s44, s44, s42
    v_mfma_f32_16x16x32_bf16 v[84:87], a[76:79], a[100:103], v[84:87]
    buffer_load_dwordx4 v8, s[12:15], s44 offen offset:0 lds
    v_mfma_f32_16x16x32_bf16 v[80:83], a[76:79], a[96:99], v[80:83]
    ds_read_b128 a[132:135], v17 offset:43008
    s_lshl3_add_u32 s51, s51, s52
    v_mfma_f32_16x16x32_bf16 v[96:99], a[80:83], a[96:99], v[96:99]
    ds_read_b64_tr_b16 a[156:157], v15 offset:17408
    s_lshl2_add_u32 s51, s51, s38
    v_mfma_f32_16x16x32_bf16 v[100:103], a[80:83], a[100:103], v[100:103]
    ds_read_b128 a[136:139], v17 offset:35840
    s_mul_i32 s51, s51, 3584
    v_mfma_f32_16x16x32_bf16 v[104:107], a[80:83], a[104:107], v[104:107]
    buffer_load_dwordx4 v8, s[16:19], s44 offen offset:1024 lds
    v_mfma_f32_16x16x32_bf16 v[108:111], a[80:83], a[108:111], v[108:111]
    ds_read_b64_tr_b16 a[158:159], v15 offset:21504
    s_and_b32 s52, s2, 8
    v_mfma_f32_16x16x32_bf16 v[124:127], a[84:87], a[108:111], v[124:127]
    ds_read_b128 a[140:143], v17 offset:44032
    s_lshl_b32 s52, s52, 24
    v_mfma_f32_16x16x32_bf16 v[120:123], a[84:87], a[104:107], v[120:123]
    s_add_u32 s51, s51, s52
    v_min_u32 v2, 27, v0
    v_lshlrev_b32_e64 v2, 7, v2
    v_mfma_f32_16x16x32_bf16 v[116:119], a[84:87], a[100:103], v[116:119]
    buffer_load_dwordx4 v9, s[12:15], s44 offen offset:2048 lds
    v_mfma_f32_16x16x32_bf16 v[112:115], a[84:87], a[96:99], v[112:115]
    buffer_load_dword v254, v2, s[24:27], s51 offen
    v_mfma_f32_16x16x32_bf16 v[128:131], a[88:91], a[96:99], v[128:131]
    s_add_u32 s65, s64, 1024
    v_lshrrev_b32_e64 v6, 4, v0
    v_and_b32 v28, 240, v26
    v_mfma_f32_16x16x32_bf16 v[132:135], a[88:91], a[100:103], v[132:135]
    s_sub_u32 s3, s64, 13312
    v_lshl_add_u32 v28, v6, 10, v28
    v_lshl_add_u32 v28, v1, 8, v28
    v_mfma_f32_16x16x32_bf16 v[136:139], a[88:91], a[104:107], v[136:139]
    buffer_load_dwordx4 v9, s[16:19], s44 offen offset:3072 lds
    v_mfma_f32_16x16x32_bf16 v[140:143], a[88:91], a[108:111], v[140:143]
    s_min_u32 s65, s65, s3
    v_and_b32 v5, 3, v0
    v_lshl_add_u32 v5, v6, 2, v5
    v_mfma_f32_16x16x32_bf16 v[156:159], a[92:95], a[108:111], v[156:159]
    s_add_u32 m0, s43, 114688
    v_lshlrev_b32_e64 v5, 4, v5
    v_bfe_u32 v6, v0, 2, 1
    v_mfma_f32_16x16x32_bf16 v[152:155], a[92:95], a[104:107], v[152:155]
    s_lshl_b32 s46, s64, 261
    v_lshl_add_u32 v29, v6, 8, v5
    v_bfe_u32 v6, v0, 2, 2
    v_mfma_f32_16x16x32_bf16 v[148:151], a[92:95], a[100:103], v[148:151]
    buffer_load_dwordx4 v18, s[24:27], s46 offen offset:0 lds
    v_mfma_f32_16x16x32_bf16 v[144:147], a[92:95], a[96:99], v[144:147]
    s_waitcnt vmcnt(16) lgkmcnt(0)
    s_barrier
    v_mfma_f32_16x16x32_bf16 v[32:35], a[112:115], a[144:147], v[32:35]
    ds_read_b64_tr_b16 a[96:97], v14 offset:32768
    v_lshl_add_u32 v5, v6, 8, v5
    v_mfma_f32_16x16x32_bf16 v[36:39], a[112:115], a[148:151], v[36:39]
    ds_read_b128 a[64:67], v16 offset:0
    v_bfe_i32 v6, v0, 3, 1
    v_mfma_f32_16x16x32_bf16 v[40:43], a[112:115], a[152:155], v[40:43]
    s_add_u32 s66, s64, 2048
    v_and_b32 v7, 1, v1
    v_xor_b32 v6, v6, v7
    v_mfma_f32_16x16x32_bf16 v[44:47], a[112:115], a[156:159], v[44:47]
    ds_read_b64_tr_b16 a[98:99], v14 offset:36864
    s_add_u32 m0, s43, 16384
    v_mfma_f32_16x16x32_bf16 v[60:63], a[116:119], a[156:159], v[60:63]
    ds_read_b128 a[68:71], v16 offset:8192
    s_xor_b32 s44, s40, 9
    v_mfma_f32_16x16x32_bf16 v[56:59], a[116:119], a[152:155], v[56:59]
    ds_read_b64_tr_b16 a[100:101], v15 offset:32768
    s_mul_i32 s44, s44, s42
    v_mfma_f32_16x16x32_bf16 v[52:55], a[116:119], a[148:151], v[52:55]
    buffer_load_dwordx4 v8, s[12:15], s44 offen offset:0 lds
    v_mfma_f32_16x16x32_bf16 v[48:51], a[116:119], a[144:147], v[48:51]
    ds_read_b128 a[72:75], v16 offset:1024
    v_and_b32_e64 v6, 3, v6
    v_mfma_f32_16x16x32_bf16 v[64:67], a[120:123], a[144:147], v[64:67]
    ds_read_b64_tr_b16 a[102:103], v15 offset:36864
    v_lshl_add_u32 v29, v6, 9, v29
    v_mfma_f32_16x16x32_bf16 v[68:71], a[120:123], a[148:151], v[68:71]
    ds_read_b128 a[76:79], v16 offset:9216
    s_sub_u32 s3, s64, 12288
    v_mfma_f32_16x16x32_bf16 v[72:75], a[120:123], a[152:155], v[72:75]
    buffer_load_dwordx4 v8, s[16:19], s44 offen offset:1024 lds
    v_mfma_f32_16x16x32_bf16 v[76:79], a[120:123], a[156:159], v[76:79]
    ds_read_b64_tr_b16 a[104:105], v14 offset:33792
    s_min_u32 s66, s66, s3
    v_mfma_f32_16x16x32_bf16 v[92:95], a[124:127], a[156:159], v[92:95]
    ds_read_b128 a[80:83], v16 offset:2048
    s_add_u32 s67, s64, 3072
    v_mfma_f32_16x16x32_bf16 v[88:91], a[124:127], a[152:155], v[88:91]
    ds_read_b64_tr_b16 a[106:107], v14 offset:37888
    s_sub_u32 s3, s64, 11264
    v_mfma_f32_16x16x32_bf16 v[84:87], a[124:127], a[148:151], v[84:87]
    buffer_load_dwordx4 v9, s[12:15], s44 offen offset:2048 lds
    v_mfma_f32_16x16x32_bf16 v[80:83], a[124:127], a[144:147], v[80:83]
    ds_read_b128 a[84:87], v16 offset:10240
    s_min_u32 s67, s67, s3
    v_mfma_f32_16x16x32_bf16 v[96:99], a[128:131], a[144:147], v[96:99]
    ds_read_b64_tr_b16 a[108:109], v15 offset:33792
    s_add_u32 s68, s64, 4096
    v_mfma_f32_16x16x32_bf16 v[100:103], a[128:131], a[148:151], v[100:103]
    ds_read_b128 a[88:91], v16 offset:3072
    s_sub_u32 s3, s64, 10240
    v_mfma_f32_16x16x32_bf16 v[104:107], a[128:131], a[152:155], v[104:107]
    buffer_load_dwordx4 v9, s[16:19], s44 offen offset:3072 lds
    v_mfma_f32_16x16x32_bf16 v[108:111], a[128:131], a[156:159], v[108:111]
    ds_read_b64_tr_b16 a[110:111], v15 offset:37888
    s_min_u32 s68, s68, s3
    v_mfma_f32_16x16x32_bf16 v[124:127], a[132:135], a[156:159], v[124:127]
    ds_read_b128 a[92:95], v16 offset:11264
    s_add_u32 m0, s43, 98304
    v_mfma_f32_16x16x32_bf16 v[120:123], a[132:135], a[152:155], v[120:123]
    s_xor_b32 s45, s41, 640
    s_add_u32 s69, s64, 5120
    s_sub_u32 s3, s64, 9216
    v_mfma_f32_16x16x32_bf16 v[116:119], a[132:135], a[148:151], v[116:119]
    buffer_load_dwordx4 v10, s[8:11], s45 offen offset:0 lds
    v_mfma_f32_16x16x32_bf16 v[112:115], a[132:135], a[144:147], v[112:115]
    s_min_u32 s69, s69, s3
    s_sub_u32 s51, 32, s49
    s_min_u32 s51, s51, s49
    v_mfma_f32_16x16x32_bf16 v[128:131], a[136:139], a[144:147], v[128:131]
    s_add_u32 s70, s64, 6144
    s_sub_u32 s3, s64, 8192
    s_min_u32 s70, s70, s3
    v_mfma_f32_16x16x32_bf16 v[132:135], a[136:139], a[148:151], v[132:135]
    s_add_u32 s71, s64, 7168
    s_sub_u32 s3, s64, 7168
    s_min_u32 s71, s71, s3
    v_mfma_f32_16x16x32_bf16 v[136:139], a[136:139], a[152:155], v[136:139]
    buffer_load_dwordx4 v11, s[8:11], s45 offen offset:1024 lds
    v_mfma_f32_16x16x32_bf16 v[140:143], a[136:139], a[156:159], v[140:143]
    s_add_u32 s72, s64, 8192
    s_sub_u32 s3, s64, 6144
    s_min_u32 s72, s72, s3
    v_mfma_f32_16x16x32_bf16 v[156:159], a[140:143], a[156:159], v[156:159]
    s_add_u32 s73, s64, 9216
    s_sub_u32 s3, s64, 5120
    s_min_u32 s73, s73, s3
    v_mfma_f32_16x16x32_bf16 v[152:155], a[140:143], a[152:155], v[152:155]
    s_add_u32 m0, s43, 114688
    s_add_u32 s74, s64, 10240
    s_sub_u32 s3, s64, 4096
    v_mfma_f32_16x16x32_bf16 v[148:151], a[140:143], a[148:151], v[148:151]
    buffer_load_dwordx4 v19, s[24:27], s46 offen offset:1024 lds
    v_mfma_f32_16x16x32_bf16 v[144:147], a[140:143], a[144:147], v[144:147]
    s_waitcnt vmcnt(17) lgkmcnt(0)
    s_barrier
    v_mfma_f32_16x16x32_bf16 v[32:35], a[64:67], a[96:99], v[32:35]
    ds_read_b64_tr_b16 a[144:145], v14 offset:49152
    s_min_u32 s74, s74, s3
    v_mfma_f32_16x16x32_bf16 v[36:39], a[64:67], a[100:103], v[36:39]
    ds_read_b128 a[112:115], v17 offset:0
    s_add_u32 s75, s64, 11264
    v_mfma_f32_16x16x32_bf16 v[40:43], a[64:67], a[104:107], v[40:43]
    s_sub_u32 s3, s64, 3072
    s_min_u32 s75, s75, s3
    s_and_b32 s51, s51, 15
    v_mfma_f32_16x16x32_bf16 v[44:47], a[64:67], a[108:111], v[44:47]
    ds_read_b64_tr_b16 a[146:147], v14 offset:53248
    s_add_u32 s76, s64, 12288
    v_mfma_f32_16x16x32_bf16 v[60:63], a[68:71], a[108:111], v[60:63]
    ds_read_b128 a[116:119], v17 offset:8192
    s_sub_u32 s3, s64, 2048
    v_mfma_f32_16x16x32_bf16 v[56:59], a[68:71], a[104:107], v[56:59]
    ds_read_b64_tr_b16 a[148:149], v15 offset:49152
    s_min_u32 s76, s76, s3
    v_mfma_f32_16x16x32_bf16 v[52:55], a[68:71], a[100:103], v[52:55]
    s_add_u32 s77, s64, 13312
    s_sub_u32 s3, s64, 1024
    s_min_u32 s77, s77, s3
    v_mfma_f32_16x16x32_bf16 v[48:51], a[68:71], a[96:99], v[48:51]
    ds_read_b128 a[120:123], v17 offset:1024
    s_lshl3_add_u32 s52, s51, s38
    v_mfma_f32_16x16x32_bf16 v[64:67], a[72:75], a[96:99], v[64:67]
    ds_read_b64_tr_b16 a[150:151], v15 offset:53248
    s_and_b32 s53, s50, 3
    v_mfma_f32_16x16x32_bf16 v[68:71], a[72:75], a[100:103], v[68:71]
    ds_read_b128 a[124:127], v17 offset:9216
    s_add_u32 m0, s43, 98304
    v_mfma_f32_16x16x32_bf16 v[72:75], a[72:75], a[104:107], v[72:75]
    buffer_load_dwordx4 v12, s[8:11], s45 offen offset:2048 lds
    v_mfma_f32_16x16x32_bf16 v[76:79], a[72:75], a[108:111], v[76:79]
    ds_read_b64_tr_b16 a[152:153], v14 offset:50176
    s_lshl2_add_u32 s52, s52, s53
    v_mfma_f32_16x16x32_bf16 v[92:95], a[76:79], a[108:111], v[92:95]
    ds_read_b128 a[128:131], v17 offset:2048
    s_lshl_b32 s52, s52, 263
    v_mfma_f32_16x16x32_bf16 v[88:91], a[76:79], a[104:107], v[88:91]
    ds_read_b64_tr_b16 a[154:155], v14 offset:54272
    s_add_u32 s58, s52, 9601024
    v_mfma_f32_16x16x32_bf16 v[84:87], a[76:79], a[100:103], v[84:87]
    buffer_load_dwordx4 v13, s[8:11], s45 offen offset:3072 lds
    v_mfma_f32_16x16x32_bf16 v[80:83], a[76:79], a[96:99], v[80:83]
    ds_read_b128 a[132:135], v17 offset:10240
    s_add_u32 m0, s43, 32768
    v_mfma_f32_16x16x32_bf16 v[96:99], a[80:83], a[96:99], v[96:99]
    ds_read_b64_tr_b16 a[156:157], v15 offset:50176
    s_xor_b32 s44, s40, 10
    v_mfma_f32_16x16x32_bf16 v[100:103], a[80:83], a[100:103], v[100:103]
    ds_read_b128 a[136:139], v17 offset:3072
    s_mul_i32 s44, s44, s42
    v_mfma_f32_16x16x32_bf16 v[104:107], a[80:83], a[104:107], v[104:107]
    buffer_load_dwordx4 v8, s[12:15], s44 offen offset:0 lds
    v_mfma_f32_16x16x32_bf16 v[108:111], a[80:83], a[108:111], v[108:111]
    ds_read_b64_tr_b16 a[158:159], v15 offset:54272
    s_add_u32 s59, s52, 9603072
    v_mfma_f32_16x16x32_bf16 v[124:127], a[84:87], a[108:111], v[124:127]
    ds_read_b128 a[140:143], v17 offset:11264
    s_mul_i32 s55, s38, 14336
    v_mfma_f32_16x16x32_bf16 v[120:123], a[84:87], a[104:107], v[120:123]
    s_mul_i32 s52, s51, 4096
    s_add_u32 s55, s55, s52
    s_lshr_b32 s52, s49, 4
    v_mfma_f32_16x16x32_bf16 v[116:119], a[84:87], a[100:103], v[116:119]
    buffer_load_dwordx4 v8, s[16:19], s44 offen offset:1024 lds
    v_mfma_f32_16x16x32_bf16 v[112:115], a[84:87], a[96:99], v[112:115]
    s_lshl_b32 s53, s52, 1
    s_sub_u32 s53, 1, s53
    s_min_u32 s54, s51, 1
    v_mfma_f32_16x16x32_bf16 v[128:131], a[88:91], a[96:99], v[128:131]
    s_xor_b32 s54, s54, 1
    s_mul_i32 s53, s53, s54
    s_add_u32 s53, s53, 2
    v_mfma_f32_16x16x32_bf16 v[132:135], a[88:91], a[100:103], v[132:135]
    s_mul_i32 s7, s53, 114688
    s_lshl2_add_u32 s51, s51, s52
    s_and_b32 s52, s38, 1
    v_mfma_f32_16x16x32_bf16 v[136:139], a[88:91], a[104:107], v[136:139]
    buffer_load_dwordx4 v9, s[12:15], s44 offen offset:2048 lds
    v_mfma_f32_16x16x32_bf16 v[140:143], a[88:91], a[108:111], v[140:143]
    s_lshl1_add_u32 s53, s51, s52
    s_xor_b32 s54, s53, 1
    s_mul_i32 s53, s53, 57344
    v_mfma_f32_16x16x32_bf16 v[156:159], a[92:95], a[108:111], v[156:159]
    s_mul_i32 s54, s54, 57344
    s_add_u32 s5, s53, s55
    s_add_u32 s6, s54, s55
    v_mfma_f32_16x16x32_bf16 v[152:155], a[92:95], a[104:107], v[152:155]
    s_lshr_b32 s53, s38, 1
    s_lshl1_add_u32 s53, s50, s53
    s_lshl_b32 s57, s53, 261
    v_mfma_f32_16x16x32_bf16 v[148:151], a[92:95], a[100:103], v[148:151]
    buffer_load_dwordx4 v9, s[16:19], s44 offen offset:3072 lds
    v_mfma_f32_16x16x32_bf16 v[144:147], a[92:95], a[96:99], v[144:147]
    s_waitcnt vmcnt(14) lgkmcnt(0)
    s_barrier
    v_mfma_f32_16x16x32_bf16 v[32:35], a[112:115], a[144:147], v[32:35]
    ds_read_b64_tr_b16 a[96:97], v14 offset:0
    s_lshl_b32 s52, s52, 276
    v_mfma_f32_16x16x32_bf16 v[36:39], a[112:115], a[148:151], v[36:39]
    ds_read_b128 a[64:67], v16 offset:16384
    s_lshl_b32 s54, s49, 266
    v_mfma_f32_16x16x32_bf16 v[40:43], a[112:115], a[152:155], v[40:43]
    buffer_load_dwordx4 v[192:195], v5, s[20:23], s62 offen offset:0 sc1
    v_mfma_f32_16x16x32_bf16 v[44:47], a[112:115], a[156:159], v[44:47]
    ds_read_b64_tr_b16 a[98:99], v14 offset:4096
    s_add_u32 s52, s52, s54
    v_mfma_f32_16x16x32_bf16 v[60:63], a[116:119], a[156:159], v[60:63]
    ds_read_b128 a[68:71], v16 offset:24576
    s_lshl1_add_u32 s48, s57, s52
    v_mfma_f32_16x16x32_bf16 v[56:59], a[116:119], a[152:155], v[56:59]
    ds_read_b64_tr_b16 a[100:101], v15 offset:0
    s_add_u32 s39, s48, 32768
    v_mfma_f32_16x16x32_bf16 v[52:55], a[116:119], a[148:151], v[52:55]
    buffer_load_dwordx4 v[196:199], v5, s[20:23], s62 offen offset:1024 sc1
    v_mfma_f32_16x16x32_bf16 v[48:51], a[116:119], a[144:147], v[48:51]
    ds_read_b128 a[72:75], v16 offset:17408
    s_sub_u32 s54, 32, s49
    v_mfma_f32_16x16x32_bf16 v[64:67], a[120:123], a[144:147], v[64:67]
    ds_read_b64_tr_b16 a[102:103], v15 offset:4096
    s_and_b32 s54, s54, 31
    v_mfma_f32_16x16x32_bf16 v[68:71], a[120:123], a[148:151], v[68:71]
    ds_read_b128 a[76:79], v16 offset:25600
    s_cmp_ge_u32 s50, 4
    s_cselect_b32 s52, -8, 8
    s_cselect_b32 s54, s54, s49
    v_mfma_f32_16x16x32_bf16 v[72:75], a[120:123], a[152:155], v[72:75]
    buffer_load_dwordx4 v[232:235], v28, s[20:23], s61 offen offset:0 sc1
    v_mfma_f32_16x16x32_bf16 v[76:79], a[120:123], a[156:159], v[76:79]
    ds_read_b64_tr_b16 a[104:105], v14 offset:1024
    s_add_u32 m0, s43, 49152
    v_mfma_f32_16x16x32_bf16 v[92:95], a[124:127], a[156:159], v[92:95]
    ds_read_b128 a[80:83], v16 offset:18432
    s_xor_b32 s44, s40, 11
    v_mfma_f32_16x16x32_bf16 v[88:91], a[124:127], a[152:155], v[88:91]
    ds_read_b64_tr_b16 a[106:107], v14 offset:5120
    s_mul_i32 s44, s44, s42
    v_mfma_f32_16x16x32_bf16 v[84:87], a[124:127], a[148:151], v[84:87]
    buffer_load_dwordx4 v8, s[12:15], s44 offen offset:0 lds
    v_mfma_f32_16x16x32_bf16 v[80:83], a[124:127], a[144:147], v[80:83]
    ds_read_b128 a[84:87], v16 offset:26624
    s_and_b32 s51, s52, 4096
    v_mfma_f32_16x16x32_bf16 v[96:99], a[128:131], a[144:147], v[96:99]
    ds_read_b64_tr_b16 a[108:109], v15 offset:1024
    s_movk_i32 s53, 2048
    v_mfma_f32_16x16x32_bf16 v[100:103], a[128:131], a[148:151], v[100:103]
    ds_read_b128 a[88:91], v16 offset:19456
    v_and_b32_e64 v220, 15, v0
    v_mfma_f32_16x16x32_bf16 v[104:107], a[128:131], a[152:155], v[104:107]
    buffer_load_dwordx4 v8, s[16:19], s44 offen offset:1024 lds
    v_mfma_f32_16x16x32_bf16 v[108:111], a[128:131], a[156:159], v[108:111]
    ds_read_b64_tr_b16 a[110:111], v15 offset:5120
    v_add_u32_e64 v220, s57, v220
    v_mfma_f32_16x16x32_bf16 v[124:127], a[132:135], a[156:159], v[124:127]
    ds_read_b128 a[92:95], v16 offset:27648
    v_mul_lo_u32 v220, v220, s52
    v_mfma_f32_16x16x32_bf16 v[120:123], a[132:135], a[152:155], v[120:123]
    buffer_load_dword v200, v29, s[20:23], s62 offen offset:12 sc1
    v_mfma_f32_16x16x32_bf16 v[116:119], a[132:135], a[148:151], v[116:119]
    buffer_load_dwordx4 v9, s[12:15], s44 offen offset:2048 lds
    v_mfma_f32_16x16x32_bf16 v[112:115], a[132:135], a[144:147], v[112:115]
    v_add_u32 v220, s51, v220
    v_lshrrev_b32 v221, 4, v0
    v_mfma_f32_16x16x32_bf16 v[128:131], a[136:139], a[144:147], v[128:131]
    v_mul_u32_u24 v221, 4352, v221
    v_mfma_f32_16x16x32_bf16 v[132:135], a[136:139], a[148:151], v[132:135]
    s_lshl_b32 s52, s52, 260
    v_add3_u32 v253, s52, v220, v221
    v_cmp_eq_u32 s[98:99], s53, v220
    v_mfma_f32_16x16x32_bf16 v[136:139], a[136:139], a[152:155], v[136:139]
    buffer_load_dwordx4 v9, s[16:19], s44 offen offset:3072 lds
    v_mfma_f32_16x16x32_bf16 v[140:143], a[136:139], a[156:159], v[140:143]
    s_mul_i32 s51, s54, 34808
    s_sub_u32 s51, 1114112, s51
    v_mov_b32_e64 v252, s51
    v_mfma_f32_16x16x32_bf16 v[156:159], a[140:143], a[156:159], v[156:159]
    s_add_u32 m0, s43, 65536
    v_cndmask_b32 v220, v220, v252, s[98:99]
    v_add_u32_e64 v252, v220, v221
    v_mfma_f32_16x16x32_bf16 v[152:155], a[140:143], a[152:155], v[152:155]
    s_xor_b32 s45, s41, 768
    s_mul_i32 s54, s54, 34816
    s_add_u32 s100, s54, 7471104
    v_mfma_f32_16x16x32_bf16 v[148:151], a[140:143], a[148:151], v[148:151]
    buffer_load_dwordx4 v10, s[8:11], s45 offen offset:0 lds
    v_mfma_f32_16x16x32_bf16 v[144:147], a[140:143], a[144:147], v[144:147]
    s_waitcnt vmcnt(18) lgkmcnt(0)
    s_barrier
    v_mfma_f32_16x16x32_bf16 v[32:35], a[64:67], a[96:99], v[32:35]
    ds_read_b64_tr_b16 a[144:145], v14 offset:16384
    s_add_u32 s101, s54, 7488512
    v_mfma_f32_16x16x32_bf16 v[36:39], a[64:67], a[100:103], v[36:39]
    ds_read_b128 a[112:115], v17 offset:16384
    v_subrev_u32 v220, 32768, v22
    v_mfma_f32_16x16x32_bf16 v[40:43], a[64:67], a[104:107], v[40:43]
    v_subrev_u32 v221, 32768, v23
    v_subrev_u32 v222, 32768, v24
    v_mfma_f32_16x16x32_bf16 v[44:47], a[64:67], a[108:111], v[44:47]
    ds_read_b64_tr_b16 a[146:147], v14 offset:20480
    v_subrev_u32 v223, 32768, v25
    v_mfma_f32_16x16x32_bf16 v[60:63], a[68:71], a[108:111], v[60:63]
    ds_read_b128 a[116:119], v17 offset:24576
    s_and_b32 s53, s37, 1
    v_mfma_f32_16x16x32_bf16 v[56:59], a[68:71], a[104:107], v[56:59]
    ds_read_b64_tr_b16 a[148:149], v15 offset:16384
    s_mul_i32 s51, s36, 2176
    v_mfma_f32_16x16x32_bf16 v[52:55], a[68:71], a[100:103], v[52:55]
    buffer_load_dwordx4 v11, s[8:11], s45 offen offset:1024 lds
    v_mfma_f32_16x16x32_bf16 v[48:51], a[68:71], a[96:99], v[48:51]
    ds_read_b128 a[120:123], v17 offset:17408
    s_add_u32 s51, s51, 7471104
    v_mfma_f32_16x16x32_bf16 v[64:67], a[72:75], a[96:99], v[64:67]
    ds_read_b64_tr_b16 a[150:151], v15 offset:20480
    s_lshl_b32 s52, s53, 7
    v_mfma_f32_16x16x32_bf16 v[68:71], a[72:75], a[100:103], v[68:71]
    ds_read_b128 a[124:127], v17 offset:25600
    s_add_u32 s52, s52, s51
    v_mfma_f32_16x16x32_bf16 v[72:75], a[72:75], a[104:107], v[72:75]
    buffer_load_dwordx4 v12, s[8:11], s45 offen offset:2048 lds
    v_mfma_f32_16x16x32_bf16 v[76:79], a[72:75], a[108:111], v[76:79]
    ds_read_b64_tr_b16 a[152:153], v14 offset:17408
    s_lshl2_add_u32 s52, s38, s52
    v_mfma_f32_16x16x32_bf16 v[92:95], a[76:79], a[108:111], v[92:95]
    ds_read_b128 a[128:131], v17 offset:18432
    s_add_u32 s52, s52, 1114112
    v_mfma_f32_16x16x32_bf16 v[88:91], a[76:79], a[104:107], v[88:91]
    ds_read_b64_tr_b16 a[154:155], v14 offset:21504
    s_lshl_b32 s54, s53, 266
    v_mfma_f32_16x16x32_bf16 v[84:87], a[76:79], a[100:103], v[84:87]
    buffer_load_dwordx4 v13, s[8:11], s45 offen offset:3072 lds
    v_mfma_f32_16x16x32_bf16 v[80:83], a[76:79], a[96:99], v[80:83]
    ds_read_b128 a[132:135], v17 offset:26624
    s_add_u32 m0, s43, 0
    v_mfma_f32_16x16x32_bf16 v[96:99], a[80:83], a[96:99], v[96:99]
    ds_read_b64_tr_b16 a[156:157], v15 offset:17408
    s_xor_b32 s44, s40, 12
    v_mfma_f32_16x16x32_bf16 v[100:103], a[80:83], a[100:103], v[100:103]
    ds_read_b128 a[136:139], v17 offset:19456
    s_mul_i32 s44, s44, s42
    v_mfma_f32_16x16x32_bf16 v[104:107], a[80:83], a[104:107], v[104:107]
    buffer_load_dwordx4 v8, s[12:15], s44 offen offset:0 lds
    v_mfma_f32_16x16x32_bf16 v[108:111], a[80:83], a[108:111], v[108:111]
    ds_read_b64_tr_b16 a[158:159], v15 offset:21504
    s_add_u32 s51, s51, s54
    v_mfma_f32_16x16x32_bf16 v[124:127], a[84:87], a[108:111], v[124:127]
    ds_read_b128 a[140:143], v17 offset:27648
    s_mov_b32 s54, 139264
    v_mfma_f32_16x16x32_bf16 v[120:123], a[84:87], a[104:107], v[120:123]
    s_mov_b32 s4, 0x80008000
    s_lshl_b32 s56, s56, 31
    v_lshrrev_b32 v4, 4, v0
    v_mfma_f32_16x16x32_bf16 v[116:119], a[84:87], a[100:103], v[116:119]
    buffer_load_dwordx4 v8, s[16:19], s44 offen offset:1024 lds
    v_mfma_f32_16x16x32_bf16 v[112:115], a[84:87], a[96:99], v[112:115]
    v_mul_lo_u32 v3, v4, s54
    v_and_b32 v2, 15, v0
    v_mfma_f32_16x16x32_bf16 v[128:131], a[88:91], a[96:99], v[128:131]
    v_lshlrev_b32 v2, 3, v2
    v_lshl_add_u32 v3, v1, 8, v3
    v_mfma_f32_16x16x32_bf16 v[132:135], a[88:91], a[100:103], v[132:135]
    v_add_u32_e64 v3, v3, v2
    v_and_or_b32 v4, v1, 2, v4
    v_mfma_f32_16x16x32_bf16 v[136:139], a[88:91], a[104:107], v[136:139]
    buffer_load_dwordx4 v9, s[12:15], s44 offen offset:2048 lds
    v_mfma_f32_16x16x32_bf16 v[140:143], a[88:91], a[108:111], v[140:143]
    v_lshl_add_u32 v2, v4, 26, v2
    v_mfma_f32_16x16x32_bf16 v[156:159], a[92:95], a[108:111], v[156:159]
    v_mfma_f32_16x16x32_bf16 v[152:155], a[92:95], a[104:107], v[152:155]
    v_mfma_f32_16x16x32_bf16 v[148:151], a[92:95], a[100:103], v[148:151]
    buffer_load_dwordx4 v9, s[16:19], s44 offen offset:3072 lds
    v_mfma_f32_16x16x32_bf16 v[144:147], a[92:95], a[96:99], v[144:147]
    s_waitcnt vmcnt(8) lgkmcnt(0)
    s_barrier
    v_mfma_f32_16x16x32_bf16 v[32:35], a[112:115], a[144:147], v[32:35]
    s_add_u32 m0, s43, 16384
    s_xor_b32 s44, s40, 13
    v_mfma_f32_16x16x32_bf16 v[36:39], a[112:115], a[148:151], v[36:39]
    ds_read_b64_tr_b16 a[96:97], v14 offset:32768
    s_mul_i32 s44, s44, s42
    v_mfma_f32_16x16x32_bf16 v[40:43], a[112:115], a[152:155], v[40:43]
    buffer_load_dwordx4 v8, s[12:15], s44 offen offset:0 lds
    v_mfma_f32_16x16x32_bf16 v[44:47], a[112:115], a[156:159], v[44:47]
    ds_read_b128 a[64:67], v16 offset:32768
    v_mfma_f32_16x16x32_bf16 v[60:63], a[116:119], a[156:159], v[60:63]
    ds_read_b64_tr_b16 a[98:99], v14 offset:36864
    v_mfma_f32_16x16x32_bf16 v[56:59], a[116:119], a[152:155], v[56:59]
    ds_read_b128 a[68:71], v17 offset:32768
    v_mfma_f32_16x16x32_bf16 v[52:55], a[116:119], a[148:151], v[52:55]
    buffer_load_dwordx4 v8, s[16:19], s44 offen offset:1024 lds
    v_mfma_f32_16x16x32_bf16 v[48:51], a[116:119], a[144:147], v[48:51]
    ds_read_b64_tr_b16 a[100:101], v15 offset:32768
    v_mfma_f32_16x16x32_bf16 v[64:67], a[120:123], a[144:147], v[64:67]
    ds_read_b128 a[72:75], v16 offset:40960
    ds_read_b64_tr_b16 a[0:1], v14 offset:49152
    v_mfma_f32_16x16x32_bf16 v[68:71], a[120:123], a[148:151], v[68:71]
    ds_read_b64_tr_b16 a[102:103], v15 offset:36864
    ds_read_b64_tr_b16 a[2:3], v14 offset:53248
    v_mfma_f32_16x16x32_bf16 v[72:75], a[120:123], a[152:155], v[72:75]
    buffer_load_dwordx4 v9, s[12:15], s44 offen offset:2048 lds
    v_mfma_f32_16x16x32_bf16 v[76:79], a[120:123], a[156:159], v[76:79]
    ds_read_b128 a[76:79], v17 offset:40960
    ds_read_b64_tr_b16 a[4:5], v15 offset:49152
    v_mfma_f32_16x16x32_bf16 v[92:95], a[124:127], a[156:159], v[92:95]
    ds_read_b64_tr_b16 a[104:105], v14 offset:33792
    ds_read_b64_tr_b16 a[6:7], v15 offset:53248
    v_mfma_f32_16x16x32_bf16 v[88:91], a[124:127], a[152:155], v[88:91]
    ds_read_b128 a[80:83], v16 offset:33792
    ds_read_b64_tr_b16 a[8:9], v14 offset:50176
    v_mfma_f32_16x16x32_bf16 v[84:87], a[124:127], a[148:151], v[84:87]
    buffer_load_dwordx4 v9, s[16:19], s44 offen offset:3072 lds
    v_mfma_f32_16x16x32_bf16 v[80:83], a[124:127], a[144:147], v[80:83]
    ds_read_b64_tr_b16 a[106:107], v14 offset:37888
    ds_read_b64_tr_b16 a[10:11], v14 offset:54272
    v_mfma_f32_16x16x32_bf16 v[96:99], a[128:131], a[144:147], v[96:99]
    ds_read_b128 a[84:87], v17 offset:33792
    s_add_u32 m0, s43, 81920
    v_mfma_f32_16x16x32_bf16 v[100:103], a[128:131], a[148:151], v[100:103]
    ds_read_b64_tr_b16 a[108:109], v15 offset:33792
    s_xor_b32 s45, s41, 896
    v_mfma_f32_16x16x32_bf16 v[104:107], a[128:131], a[152:155], v[104:107]
    buffer_load_dwordx4 v10, s[8:11], s45 offen offset:0 lds
    v_mfma_f32_16x16x32_bf16 v[108:111], a[128:131], a[156:159], v[108:111]
    ds_read_b128 a[88:91], v16 offset:41984
    ds_read_b64_tr_b16 a[12:13], v15 offset:50176
    v_mfma_f32_16x16x32_bf16 v[124:127], a[132:135], a[156:159], v[124:127]
    ds_read_b64_tr_b16 a[110:111], v15 offset:37888
    ds_read_b64_tr_b16 a[14:15], v15 offset:54272
    v_mfma_f32_16x16x32_bf16 v[120:123], a[132:135], a[152:155], v[120:123]
    ds_read_b128 a[92:95], v17 offset:41984
    s_waitcnt vmcnt(15)
    v_mfma_f32_16x16x32_bf16 v[116:119], a[132:135], a[148:151], v[116:119]
    buffer_load_dwordx4 v11, s[8:11], s45 offen offset:1024 lds
    v_mfma_f32_16x16x32_bf16 v[112:115], a[132:135], a[144:147], v[112:115]
    v_max3_u32 v30, v235, v234, v233
    v_max3_u32 v30, v30, v232, v200
    v_mfma_f32_16x16x32_bf16 v[128:131], a[136:139], a[144:147], v[128:131]
    v_max3_u32 v30, v30, v199, v198
    v_max3_u32 v30, v30, v197, v196
    v_mfma_f32_16x16x32_bf16 v[132:135], a[136:139], a[148:151], v[132:135]
    v_max3_u32 v30, v30, v195, v194
    v_max3_u32 v30, v30, v193, v192
    v_mfma_f32_16x16x32_bf16 v[136:139], a[136:139], a[152:155], v[136:139]
    buffer_load_dwordx4 v12, s[8:11], s45 offen offset:2048 lds
    v_mfma_f32_16x16x32_bf16 v[140:143], a[136:139], a[156:159], v[140:143]
    v_cmp_eq_u32 vcc, -1, v30
    v_mfma_f32_16x16x32_bf16 v[156:159], a[140:143], a[156:159], v[156:159]
    s_cbranch_vccnz dg_spin
dg_back:
    v_mfma_f32_16x16x32_bf16 v[152:155], a[140:143], a[152:155], v[152:155]
    v_mov_b32_dpp v201, v200 quad_perm:[1,0,3,2] row_mask:0xf bank_mask:0xf
    v_cvt_pk_bf16_f32 v200, v200, v201
    v_mfma_f32_16x16x32_bf16 v[148:151], a[140:143], a[148:151], v[148:151]
    buffer_load_dwordx4 v13, s[8:11], s45 offen offset:3072 lds
    v_mfma_f32_16x16x32_bf16 v[144:147], a[140:143], a[144:147], v[144:147]
    s_waitcnt vmcnt(8) lgkmcnt(0)
    s_barrier
    v_mfma_f32_16x16x32_bf16 v[32:35], a[64:67], a[96:99], v[32:35]
    s_add_u32 m0, s43, 32768
    s_xor_b32 s44, s40, 14
    v_mov_b32_dpp v224, v200 row_newbcast:0 row_mask:0xf bank_mask:0xf
    v_mfma_f32_16x16x32_bf16 v[32:35], a[68:71], a[0:3], v[32:35]
    ds_read_b64_tr_b16 a[144:145], v14 offset:0
    s_mul_i32 s44, s44, s42
    v_mfma_f32_16x16x32_bf16 v[36:39], a[68:71], a[4:7], v[36:39]
k_pad10:
    s_cbranch_execz k_padback
    s_nop 0
    buffer_load_dwordx4 v8, s[12:15], s44 offen offset:0 lds
    v_mfma_f32_16x16x32_bf16 v[36:39], a[64:67], a[100:103], v[36:39]
    ds_read_b128 a[112:115], v16 offset:34816
    v_permlane32_swap_b32 v232, v234
    v_mfma_f32_16x16x32_bf16 v[40:43], a[64:67], a[104:107], v[40:43]
    ds_read_b64_tr_b16 a[146:147], v14 offset:4096
    v_permlane32_swap_b32_e64 v233, v235
    v_mfma_f32_16x16x32_bf16 v[40:43], a[68:71], a[8:11], v[40:43]
    ds_read_b128 a[116:119], v17 offset:34816
    v_add_f32_e64 v232, v232, v234
    v_mfma_f32_16x16x32_bf16 v[44:47], a[68:71], a[12:15], v[44:47]
    buffer_load_dwordx4 v8, s[16:19], s44 offen offset:1024 lds
    v_mfma_f32_16x16x32_bf16 v[44:47], a[64:67], a[108:111], v[44:47]
    ds_read_b64_tr_b16 a[148:149], v15 offset:0
    v_add_f32_e64 v233, v233, v235
    v_mfma_f32_16x16x32_bf16 v[60:63], a[72:75], a[108:111], v[60:63]
    ds_read_b128 a[120:123], v16 offset:43008
    v_mul_f32 v194, 0xbf317218, v194
    v_mfma_f32_16x16x32_bf16 v[60:63], a[76:79], a[12:15], v[60:63]
    ds_read_b64_tr_b16 a[150:151], v15 offset:4096
    v_mul_f32 v198, 0xbf317218, v198
    v_mfma_f32_16x16x32_bf16 v[56:59], a[76:79], a[8:11], v[56:59]
    buffer_load_dwordx4 v9, s[12:15], s44 offen offset:2048 lds
    v_mfma_f32_16x16x32_bf16 v[56:59], a[72:75], a[104:107], v[56:59]
    ds_read_b128 a[124:127], v17 offset:43008
    v_permlane16_swap_b32_e64 v232, v233
    v_mfma_f32_16x16x32_bf16 v[52:55], a[72:75], a[100:103], v[52:55]
    ds_read_b64_tr_b16 a[152:153], v14 offset:1024
    v_add_f32_e64 v232, v232, v233
    v_mfma_f32_16x16x32_bf16 v[52:55], a[76:79], a[4:7], v[52:55]
    ds_read_b128 a[128:131], v16 offset:35840
    v_mov_b32_e64 v234, v232
    v_mfma_f32_16x16x32_bf16 v[48:51], a[76:79], a[0:3], v[48:51]
    buffer_load_dwordx4 v9, s[16:19], s44 offen offset:3072 lds
    v_mfma_f32_16x16x32_bf16 v[48:51], a[72:75], a[96:99], v[48:51]
    ds_read_b64_tr_b16 a[154:155], v14 offset:5120
    s_add_u32 m0, s43, 49152
    v_mfma_f32_16x16x32_bf16 v[64:67], a[80:83], a[96:99], v[64:67]
    ds_read_b128 a[132:135], v17 offset:35840
    s_xor_b32 s44, s40, 15
    v_mfma_f32_16x16x32_bf16 v[64:67], a[84:87], a[0:3], v[64:67]
    ds_read_b64_tr_b16 a[156:157], v15 offset:1024
    s_mul_i32 s44, s44, s42
    v_mfma_f32_16x16x32_bf16 v[68:71], a[84:87], a[4:7], v[68:71]
    buffer_load_dwordx4 v8, s[12:15], s44 offen offset:0 lds
    v_mfma_f32_16x16x32_bf16 v[68:71], a[80:83], a[100:103], v[68:71]
    ds_read_b128 a[136:139], v16 offset:44032
    v_permlane32_swap_b32_e64 v232, v234
    v_mfma_f32_16x16x32_bf16 v[72:75], a[80:83], a[104:107], v[72:75]
    ds_read_b64_tr_b16 a[158:159], v15 offset:5120
    v_mov_b32_e64 v233, v232
    v_mfma_f32_16x16x32_bf16 v[72:75], a[84:87], a[8:11], v[72:75]
    ds_read_b128 a[140:143], v17 offset:44032
    v_mov_b32_e64 v235, v234
    v_mfma_f32_16x16x32_bf16 v[76:79], a[84:87], a[12:15], v[76:79]
    buffer_load_dwordx4 v8, s[16:19], s44 offen offset:1024 lds
    v_mfma_f32_16x16x32_bf16 v[76:79], a[80:83], a[108:111], v[76:79]
    v_permlane16_swap_b32 v232, v233
    v_mfma_f32_16x16x32_bf16 v[92:95], a[88:91], a[108:111], v[92:95]
    v_permlane16_swap_b32 v234, v235
    v_mfma_f32_16x16x32_bf16 v[92:95], a[92:95], a[12:15], v[92:95]
    v_mov_b32_dpp v225, v200 row_newbcast:2 row_mask:0xf bank_mask:0xf
    v_mov_b32_dpp v226, v200 row_newbcast:4 row_mask:0xf bank_mask:0xf
    v_mfma_f32_16x16x32_bf16 v[88:91], a[92:95], a[8:11], v[88:91]
    buffer_load_dwordx4 v9, s[12:15], s44 offen offset:2048 lds
    v_mfma_f32_16x16x32_bf16 v[88:91], a[88:91], a[104:107], v[88:91]
    v_mov_b32_dpp v227, v200 row_newbcast:6 row_mask:0xf bank_mask:0xf
    v_mov_b32_dpp v228, v200 row_newbcast:8 row_mask:0xf bank_mask:0xf
    v_mfma_f32_16x16x32_bf16 v[84:87], a[88:91], a[100:103], v[84:87]
    v_mov_b32_dpp v229, v200 row_newbcast:10 row_mask:0xf bank_mask:0xf
    v_mov_b32_dpp v230, v200 row_newbcast:12 row_mask:0xf bank_mask:0xf
    v_mfma_f32_16x16x32_bf16 v[84:87], a[92:95], a[4:7], v[84:87]
    v_mov_b32_dpp v231, v200 row_newbcast:14 row_mask:0xf bank_mask:0xf
    v_xor_b32_e64 v200, s4, v228
    v_mfma_f32_16x16x32_bf16 v[80:83], a[92:95], a[0:3], v[80:83]
    buffer_load_dwordx4 v9, s[16:19], s44 offen offset:3072 lds
    v_mfma_f32_16x16x32_bf16 v[80:83], a[88:91], a[96:99], v[80:83]
    s_waitcnt vmcnt(12) lgkmcnt(0)
    s_barrier
    v_mfma_f32_16x16x32_bf16 v[96:99], a[112:115], a[96:99], v[96:99]
    ds_read_b64_tr_b16 a[16:17], v14 offset:16384
    v_xor_b32_e64 v201, s4, v229
    v_mfma_f32_16x16x32_bf16 v[96:99], a[116:119], a[0:3], v[96:99]
    ds_read_b128 a[64:67], v16 offset:0
    s_add_u32 m0, s43, 114688
    v_mfma_f32_16x16x32_bf16 v[100:103], a[116:119], a[4:7], v[100:103]
    buffer_load_dwordx4 v20, s[24:27], s46 offen offset:2048 lds
    v_mfma_f32_16x16x32_bf16 v[100:103], a[112:115], a[100:103], v[100:103]
    ds_read_b64_tr_b16 a[18:19], v14 offset:20480
    v_xor_b32_e64 v202, s4, v230
    v_mfma_f32_16x16x32_bf16 v[104:107], a[112:115], a[104:107], v[104:107]
    ds_read_b128 a[68:71], v17 offset:0
    v_xor_b32_e64 v203, s4, v231
    v_mfma_f32_16x16x32_bf16 v[104:107], a[116:119], a[8:11], v[104:107]
    ds_read_b64_tr_b16 a[20:21], v15 offset:16384
    v_fmac_f32_dpp v32, v192, v232 row_newbcast:0 row_mask:0xf bank_mask:0xf
    v_mfma_f32_16x16x32_bf16 v[108:111], a[116:119], a[12:15], v[108:111]
    buffer_load_dwordx4 v21, s[24:27], s46 offen offset:3072 lds
    v_mfma_f32_16x16x32_bf16 v[108:111], a[112:115], a[108:111], v[108:111]
    ds_read_b128 a[72:75], v16 offset:8192
    v_fmac_f32_dpp v33, v192, v232 row_newbcast:1 row_mask:0xf bank_mask:0xf
    v_mfma_f32_16x16x32_bf16 v[124:127], a[120:123], a[108:111], v[124:127]
    ds_read_b64_tr_b16 a[22:23], v15 offset:20480
    s_add_u32 m0, s43, 131072
    v_mfma_f32_16x16x32_bf16 v[124:127], a[124:127], a[12:15], v[124:127]
    ds_read_b128 a[76:79], v17 offset:8192
    s_lshl_b32 s46, s65, 261
    v_mfma_f32_16x16x32_bf16 v[120:123], a[124:127], a[8:11], v[120:123]
    buffer_load_dwordx4 v18, s[24:27], s46 offen offset:0 lds
    v_mfma_f32_16x16x32_bf16 v[120:123], a[120:123], a[104:107], v[120:123]
    ds_read_b64_tr_b16 a[24:25], v14 offset:17408
    v_fmac_f32_dpp v34, v192, v232 row_newbcast:2 row_mask:0xf bank_mask:0xf
    v_mfma_f32_16x16x32_bf16 v[116:119], a[120:123], a[100:103], v[116:119]
    ds_read_b128 a[80:83], v16 offset:1024
    v_fmac_f32_dpp v35, v192, v232 row_newbcast:3 row_mask:0xf bank_mask:0xf
    v_mfma_f32_16x16x32_bf16 v[116:119], a[124:127], a[4:7], v[116:119]
    ds_read_b64_tr_b16 a[26:27], v14 offset:21504
    v_fmac_f32_dpp v36, v192, v233 row_newbcast:0 row_mask:0xf bank_mask:0xf
    v_mfma_f32_16x16x32_bf16 v[112:115], a[124:127], a[0:3], v[112:115]
    buffer_load_dwordx4 v19, s[24:27], s46 offen offset:1024 lds
    v_mfma_f32_16x16x32_bf16 v[112:115], a[120:123], a[96:99], v[112:115]
    ds_read_b128 a[84:87], v17 offset:1024
    v_fmac_f32_dpp v37, v192, v233 row_newbcast:1 row_mask:0xf bank_mask:0xf
    v_mfma_f32_16x16x32_bf16 v[128:131], a[128:131], a[96:99], v[128:131]
    ds_read_b64_tr_b16 a[28:29], v15 offset:17408
    v_fmac_f32_dpp v38, v192, v233 row_newbcast:2 row_mask:0xf bank_mask:0xf
    v_mfma_f32_16x16x32_bf16 v[128:131], a[132:135], a[0:3], v[128:131]
    ds_read_b128 a[88:91], v16 offset:9216
    v_fmac_f32_dpp v39, v192, v233 row_newbcast:3 row_mask:0xf bank_mask:0xf
    v_mfma_f32_16x16x32_bf16 v[132:135], a[132:135], a[4:7], v[132:135]
    buffer_load_dwordx4 v20, s[24:27], s46 offen offset:2048 lds
    v_mfma_f32_16x16x32_bf16 v[132:135], a[128:131], a[100:103], v[132:135]
    ds_read_b64_tr_b16 a[30:31], v15 offset:21504
    v_fmac_f32_dpp v40, v192, v234 row_newbcast:0 row_mask:0xf bank_mask:0xf
    v_mfma_f32_16x16x32_bf16 v[136:139], a[128:131], a[104:107], v[136:139]
    ds_read_b128 a[92:95], v17 offset:9216
    v_fmac_f32_dpp v41, v192, v234 row_newbcast:1 row_mask:0xf bank_mask:0xf
    v_mfma_f32_16x16x32_bf16 v[136:139], a[132:135], a[8:11], v[136:139]
    v_fmac_f32_dpp v42, v192, v234 row_newbcast:2 row_mask:0xf bank_mask:0xf
    v_fmac_f32_dpp v43, v192, v234 row_newbcast:3 row_mask:0xf bank_mask:0xf
    v_mfma_f32_16x16x32_bf16 v[140:143], a[132:135], a[12:15], v[140:143]
    buffer_load_dwordx4 v21, s[24:27], s46 offen offset:3072 lds
    v_mfma_f32_16x16x32_bf16 v[140:143], a[128:131], a[108:111], v[140:143]
    v_fmac_f32_dpp v44, v192, v235 row_newbcast:0 row_mask:0xf bank_mask:0xf
    v_fmac_f32_dpp v45, v192, v235 row_newbcast:1 row_mask:0xf bank_mask:0xf
    v_mfma_f32_16x16x32_bf16 v[156:159], a[136:139], a[108:111], v[156:159]
    s_add_u32 m0, s43, 98304
    v_fmac_f32_dpp v46, v192, v235 row_newbcast:2 row_mask:0xf bank_mask:0xf
    v_fmac_f32_dpp v47, v192, v235 row_newbcast:3 row_mask:0xf bank_mask:0xf
    v_mfma_f32_16x16x32_bf16 v[156:159], a[140:143], a[12:15], v[156:159]
    s_lshl_b32 s46, s66, 261
    v_fmac_f32_dpp v48, v192, v232 row_newbcast:4 row_mask:0xf bank_mask:0xf
    v_fmac_f32_dpp v49, v192, v232 row_newbcast:5 row_mask:0xf bank_mask:0xf
    v_mfma_f32_16x16x32_bf16 v[152:155], a[140:143], a[8:11], v[152:155]
    buffer_load_dwordx4 v18, s[24:27], s46 offen offset:0 lds
    v_mfma_f32_16x16x32_bf16 v[152:155], a[136:139], a[104:107], v[152:155]
    v_fmac_f32_dpp v50, v192, v232 row_newbcast:6 row_mask:0xf bank_mask:0xf
    v_fmac_f32_dpp v51, v192, v232 row_newbcast:7 row_mask:0xf bank_mask:0xf
    v_mfma_f32_16x16x32_bf16 v[148:151], a[136:139], a[100:103], v[148:151]
    v_fmac_f32_dpp v52, v192, v233 row_newbcast:4 row_mask:0xf bank_mask:0xf
    v_fmac_f32_dpp v53, v192, v233 row_newbcast:5 row_mask:0xf bank_mask:0xf
    v_mfma_f32_16x16x32_bf16 v[148:151], a[140:143], a[4:7], v[148:151]
    v_fmac_f32_dpp v54, v192, v233 row_newbcast:6 row_mask:0xf bank_mask:0xf
    v_fmac_f32_dpp v55, v192, v233 row_newbcast:7 row_mask:0xf bank_mask:0xf
    v_mfma_f32_16x16x32_bf16 v[144:147], a[140:143], a[0:3], v[144:147]
    v_fmac_f32_dpp v56, v192, v234 row_newbcast:4 row_mask:0xf bank_mask:0xf
    v_fmac_f32_dpp v57, v192, v234 row_newbcast:5 row_mask:0xf bank_mask:0xf
    v_mfma_f32_16x16x32_bf16 v[144:147], a[136:139], a[96:99], v[144:147]
    s_waitcnt vmcnt(11) lgkmcnt(0)
    s_barrier
    v_mfma_f32_16x16x32_bf16 v[32:35], a[64:67], a[144:147], v[32:35]
    ds_read_b64_tr_b16 a[96:97], v14 offset:32768
    v_add_u32_e64 v8, s5, v26
    v_mfma_f32_16x16x32_bf16 v[32:35], a[68:71], a[16:19], v[32:35]
    ds_read_b128 a[112:115], v16 offset:2048
    v_add_u32_e64 v9, s6, v26
    v_mfma_f32_16x16x32_bf16 v[36:39], a[68:71], a[20:23], v[36:39]
    buffer_load_dwordx4 v19, s[24:27], s46 offen offset:1024 lds
    v_mfma_f32_16x16x32_bf16 v[36:39], a[64:67], a[148:151], v[36:39]
    ds_read_b64_tr_b16 a[98:99], v14 offset:36864
    v_add_u32_e64 v10, s7, v8
    v_mfma_f32_16x16x32_bf16 v[40:43], a[64:67], a[152:155], v[40:43]
    ds_read_b128 a[116:119], v17 offset:2048
    v_add_u32_e64 v11, s7, v9
    v_mfma_f32_16x16x32_bf16 v[40:43], a[68:71], a[24:27], v[40:43]
    ds_read_b64_tr_b16 a[100:101], v15 offset:32768
    v_bfe_u32 v12, v0, 4, 1
    v_mfma_f32_16x16x32_bf16 v[44:47], a[68:71], a[28:31], v[44:47]
    buffer_load_dwordx4 v20, s[24:27], s46 offen offset:2048 lds
    v_mfma_f32_16x16x32_bf16 v[44:47], a[64:67], a[156:159], v[44:47]
    ds_read_b128 a[120:123], v16 offset:10240
    v_lshrrev_b32_e64 v13, 5, v0
    v_mfma_f32_16x16x32_bf16 v[60:63], a[72:75], a[156:159], v[60:63]
    ds_read_b64_tr_b16 a[102:103], v15 offset:36864
    v_lshl_add_u32 v12, v12, 1, v13
    v_mfma_f32_16x16x32_bf16 v[60:63], a[76:79], a[28:31], v[60:63]
    ds_read_b128 a[124:127], v17 offset:10240
    v_and_b32_e64 v13, 15, v0
    v_mfma_f32_16x16x32_bf16 v[56:59], a[76:79], a[24:27], v[56:59]
    buffer_load_dwordx4 v21, s[24:27], s46 offen offset:3072 lds
    v_mfma_f32_16x16x32_bf16 v[56:59], a[72:75], a[152:155], v[56:59]
    ds_read_b64_tr_b16 a[104:105], v14 offset:33792
    v_lshl_add_u32 v12, v13, 12, v12
    v_mfma_f32_16x16x32_bf16 v[52:55], a[72:75], a[148:151], v[52:55]
    ds_read_b128 a[128:131], v16 offset:3072
    s_add_u32 m0, s43, 147456
    v_mfma_f32_16x16x32_bf16 v[52:55], a[76:79], a[20:23], v[52:55]
    ds_read_b64_tr_b16 a[106:107], v14 offset:37888
    s_lshl_b32 s46, s67, 261
    v_mfma_f32_16x16x32_bf16 v[48:51], a[76:79], a[16:19], v[48:51]
    buffer_load_dwordx4 v18, s[24:27], s46 offen offset:0 lds
    v_mfma_f32_16x16x32_bf16 v[48:51], a[72:75], a[144:147], v[48:51]
    ds_read_b128 a[132:135], v17 offset:3072
    v_lshlrev_b32_e64 v12, 4, v12
    v_mfma_f32_16x16x32_bf16 v[64:67], a[80:83], a[144:147], v[64:67]
    ds_read_b64_tr_b16 a[108:109], v15 offset:33792
    v_fmac_f32_dpp v72, v192, v234 row_newbcast:8 row_mask:0xf bank_mask:0xf
    v_mfma_f32_16x16x32_bf16 v[64:67], a[84:87], a[16:19], v[64:67]
    ds_read_b128 a[136:139], v16 offset:11264
    v_fmac_f32_dpp v60, v192, v235 row_newbcast:4 row_mask:0xf bank_mask:0xf
    v_mfma_f32_16x16x32_bf16 v[68:71], a[84:87], a[20:23], v[68:71]
    buffer_load_dwordx4 v19, s[24:27], s46 offen offset:1024 lds
    v_mfma_f32_16x16x32_bf16 v[68:71], a[80:83], a[148:151], v[68:71]
    ds_read_b64_tr_b16 a[110:111], v15 offset:37888
    v_fmac_f32_dpp v58, v192, v234 row_newbcast:6 row_mask:0xf bank_mask:0xf
    v_mfma_f32_16x16x32_bf16 v[72:75], a[80:83], a[152:155], v[72:75]
    ds_read_b128 a[140:143], v17 offset:11264
    v_fmac_f32_dpp v59, v192, v234 row_newbcast:7 row_mask:0xf bank_mask:0xf
    v_mfma_f32_16x16x32_bf16 v[72:75], a[84:87], a[24:27], v[72:75]
    v_fmac_f32_dpp v61, v192, v235 row_newbcast:5 row_mask:0xf bank_mask:0xf
    v_fmac_f32_dpp v62, v192, v235 row_newbcast:6 row_mask:0xf bank_mask:0xf
    v_mfma_f32_16x16x32_bf16 v[76:79], a[84:87], a[28:31], v[76:79]
    buffer_load_dwordx4 v20, s[24:27], s46 offen offset:2048 lds
    v_mfma_f32_16x16x32_bf16 v[76:79], a[80:83], a[156:159], v[76:79]
    v_fmac_f32_dpp v63, v192, v235 row_newbcast:7 row_mask:0xf bank_mask:0xf
    v_fmac_f32_dpp v80, v192, v232 row_newbcast:12 row_mask:0xf bank_mask:0xf
    v_mfma_f32_16x16x32_bf16 v[92:95], a[88:91], a[156:159], v[92:95]
    v_fmac_f32_dpp v81, v192, v232 row_newbcast:13 row_mask:0xf bank_mask:0xf
    v_fmac_f32_dpp v82, v192, v232 row_newbcast:14 row_mask:0xf bank_mask:0xf
    v_mfma_f32_16x16x32_bf16 v[92:95], a[92:95], a[28:31], v[92:95]
    v_fmac_f32_dpp v64, v192, v232 row_newbcast:8 row_mask:0xf bank_mask:0xf
    v_fmac_f32_dpp v65, v192, v232 row_newbcast:9 row_mask:0xf bank_mask:0xf
    v_mfma_f32_16x16x32_bf16 v[88:91], a[92:95], a[24:27], v[88:91]
    buffer_load_dwordx4 v21, s[24:27], s46 offen offset:3072 lds
    v_mfma_f32_16x16x32_bf16 v[88:91], a[88:91], a[152:155], v[88:91]
    v_fmac_f32_dpp v66, v192, v232 row_newbcast:10 row_mask:0xf bank_mask:0xf
    v_fmac_f32_dpp v67, v192, v232 row_newbcast:11 row_mask:0xf bank_mask:0xf
    v_mfma_f32_16x16x32_bf16 v[84:87], a[88:91], a[148:151], v[84:87]
    s_add_u32 m0, s43, 0
    v_fmac_f32_dpp v68, v192, v233 row_newbcast:8 row_mask:0xf bank_mask:0xf
    v_fmac_f32_dpp v69, v192, v233 row_newbcast:9 row_mask:0xf bank_mask:0xf
    v_mfma_f32_16x16x32_bf16 v[84:87], a[92:95], a[20:23], v[84:87]
    s_lshl_b32 s46, s68, 5
    v_fmac_f32_dpp v70, v192, v233 row_newbcast:10 row_mask:0xf bank_mask:0xf
    v_fmac_f32_dpp v71, v192, v233 row_newbcast:11 row_mask:0xf bank_mask:0xf
    v_mfma_f32_16x16x32_bf16 v[80:83], a[92:95], a[16:19], v[80:83]
    buffer_load_dwordx4 v18, s[24:27], s46 offen offset:0 lds
    v_mfma_f32_16x16x32_bf16 v[80:83], a[88:91], a[144:147], v[80:83]
    s_waitcnt vmcnt(15) lgkmcnt(0)
    s_barrier
    v_mfma_f32_16x16x32_bf16 v[96:99], a[112:115], a[144:147], v[96:99]
    ds_read_b64_tr_b16 a[0:1], v14 offset:49152
    v_fmac_f32_dpp v73, v192, v234 row_newbcast:9 row_mask:0xf bank_mask:0xf
    v_mfma_f32_16x16x32_bf16 v[96:99], a[116:119], a[16:19], v[96:99]
    ds_read_b128 a[64:67], v16 offset:16384
    v_fmac_f32_dpp v74, v192, v234 row_newbcast:10 row_mask:0xf bank_mask:0xf
    v_mfma_f32_16x16x32_bf16 v[100:103], a[116:119], a[20:23], v[100:103]
    v_fmac_f32_dpp v75, v192, v234 row_newbcast:11 row_mask:0xf bank_mask:0xf
    v_fmac_f32_dpp v76, v192, v235 row_newbcast:8 row_mask:0xf bank_mask:0xf
    v_mfma_f32_16x16x32_bf16 v[100:103], a[112:115], a[148:151], v[100:103]
    ds_read_b64_tr_b16 a[2:3], v14 offset:53248
    v_fmac_f32_dpp v77, v192, v235 row_newbcast:9 row_mask:0xf bank_mask:0xf
    v_mfma_f32_16x16x32_bf16 v[104:107], a[112:115], a[152:155], v[104:107]
    ds_read_b128 a[68:71], v17 offset:16384
    v_fmac_f32_dpp v78, v192, v235 row_newbcast:10 row_mask:0xf bank_mask:0xf
    v_mfma_f32_16x16x32_bf16 v[104:107], a[116:119], a[24:27], v[104:107]
    ds_read_b64_tr_b16 a[4:5], v15 offset:49152
    v_fmac_f32_dpp v79, v192, v235 row_newbcast:11 row_mask:0xf bank_mask:0xf
    v_mfma_f32_16x16x32_bf16 v[108:111], a[116:119], a[28:31], v[108:111]
    buffer_load_dwordx4 v19, s[24:27], s46 offen offset:1024 lds
    v_mfma_f32_16x16x32_bf16 v[108:111], a[112:115], a[156:159], v[108:111]
    ds_read_b128 a[72:75], v16 offset:24576
    v_fmac_f32_dpp v83, v192, v232 row_newbcast:15 row_mask:0xf bank_mask:0xf
    v_mfma_f32_16x16x32_bf16 v[124:127], a[120:123], a[156:159], v[124:127]
    ds_read_b64_tr_b16 a[6:7], v15 offset:53248
    v_fmac_f32_dpp v84, v192, v233 row_newbcast:12 row_mask:0xf bank_mask:0xf
    v_mfma_f32_16x16x32_bf16 v[124:127], a[124:127], a[28:31], v[124:127]
    ds_read_b128 a[76:79], v17 offset:24576
    v_fmac_f32_dpp v85, v192, v233 row_newbcast:13 row_mask:0xf bank_mask:0xf
    v_mfma_f32_16x16x32_bf16 v[120:123], a[124:127], a[24:27], v[120:123]
    buffer_load_dwordx4 v20, s[24:27], s46 offen offset:2048 lds
    v_mfma_f32_16x16x32_bf16 v[120:123], a[120:123], a[152:155], v[120:123]
    ds_read_b64_tr_b16 a[8:9], v14 offset:50176
    v_fmac_f32_dpp v86, v192, v233 row_newbcast:14 row_mask:0xf bank_mask:0xf
    v_mfma_f32_16x16x32_bf16 v[116:119], a[120:123], a[148:151], v[116:119]
    ds_read_b128 a[80:83], v16 offset:17408
    v_fmac_f32_dpp v87, v192, v233 row_newbcast:15 row_mask:0xf bank_mask:0xf
    v_mfma_f32_16x16x32_bf16 v[116:119], a[124:127], a[20:23], v[116:119]
    ds_read_b64_tr_b16 a[10:11], v14 offset:54272
    v_fmac_f32_dpp v88, v192, v234 row_newbcast:12 row_mask:0xf bank_mask:0xf
    v_mfma_f32_16x16x32_bf16 v[112:115], a[124:127], a[16:19], v[112:115]
    buffer_load_dwordx4 v21, s[24:27], s46 offen offset:3072 lds
    v_mfma_f32_16x16x32_bf16 v[112:115], a[120:123], a[144:147], v[112:115]
    ds_read_b128 a[84:87], v17 offset:17408
    v_fmac_f32_dpp v89, v192, v234 row_newbcast:13 row_mask:0xf bank_mask:0xf
    v_mfma_f32_16x16x32_bf16 v[128:131], a[128:131], a[144:147], v[128:131]
    ds_read_b64_tr_b16 a[12:13], v15 offset:50176
    s_add_u32 m0, s43, 16384
    v_mfma_f32_16x16x32_bf16 v[128:131], a[132:135], a[16:19], v[128:131]
    ds_read_b128 a[88:91], v16 offset:25600
    s_lshl_b32 s46, s69, 261
    v_mfma_f32_16x16x32_bf16 v[132:135], a[132:135], a[20:23], v[132:135]
    buffer_load_dwordx4 v18, s[24:27], s46 offen offset:0 lds
    v_mfma_f32_16x16x32_bf16 v[132:135], a[128:131], a[148:151], v[132:135]
    ds_read_b64_tr_b16 a[14:15], v15 offset:54272
    v_fmac_f32_dpp v90, v192, v234 row_newbcast:14 row_mask:0xf bank_mask:0xf
    v_mfma_f32_16x16x32_bf16 v[136:139], a[128:131], a[152:155], v[136:139]
    ds_read_b128 a[92:95], v17 offset:25600
    v_fmac_f32_dpp v91, v192, v234 row_newbcast:15 row_mask:0xf bank_mask:0xf
    v_mfma_f32_16x16x32_bf16 v[136:139], a[132:135], a[24:27], v[136:139]
    v_fmac_f32_dpp v92, v192, v235 row_newbcast:12 row_mask:0xf bank_mask:0xf
    v_fmac_f32_dpp v93, v192, v235 row_newbcast:13 row_mask:0xf bank_mask:0xf
    v_mfma_f32_16x16x32_bf16 v[140:143], a[132:135], a[28:31], v[140:143]
    buffer_load_dwordx4 v19, s[24:27], s46 offen offset:1024 lds
    v_mfma_f32_16x16x32_bf16 v[140:143], a[128:131], a[156:159], v[140:143]
    v_fmac_f32_dpp v94, v192, v235 row_newbcast:14 row_mask:0xf bank_mask:0xf
    v_fmac_f32_dpp v95, v192, v235 row_newbcast:15 row_mask:0xf bank_mask:0xf
    v_mfma_f32_16x16x32_bf16 v[156:159], a[136:139], a[156:159], v[156:159]
    v_fmac_f32_dpp v96, v196, v232 row_newbcast:0 row_mask:0xf bank_mask:0xf
    v_fmac_f32_dpp v97, v196, v232 row_newbcast:1 row_mask:0xf bank_mask:0xf
    v_mfma_f32_16x16x32_bf16 v[156:159], a[140:143], a[28:31], v[156:159]
    v_fmac_f32_dpp v98, v196, v232 row_newbcast:2 row_mask:0xf bank_mask:0xf
    v_fmac_f32_dpp v99, v196, v232 row_newbcast:3 row_mask:0xf bank_mask:0xf
    v_mfma_f32_16x16x32_bf16 v[152:155], a[140:143], a[24:27], v[152:155]
    buffer_load_dwordx4 v20, s[24:27], s46 offen offset:2048 lds
    v_mfma_f32_16x16x32_bf16 v[152:155], a[136:139], a[152:155], v[152:155]
    v_fmac_f32_dpp v100, v196, v233 row_newbcast:0 row_mask:0xf bank_mask:0xf
    v_fmac_f32_dpp v101, v196, v233 row_newbcast:1 row_mask:0xf bank_mask:0xf
    v_mfma_f32_16x16x32_bf16 v[148:151], a[136:139], a[148:151], v[148:151]
    v_fmac_f32_dpp v102, v196, v233 row_newbcast:2 row_mask:0xf bank_mask:0xf
    v_fmac_f32_dpp v103, v196, v233 row_newbcast:3 row_mask:0xf bank_mask:0xf
    v_mfma_f32_16x16x32_bf16 v[148:151], a[140:143], a[20:23], v[148:151]
    v_fmac_f32_dpp v104, v196, v234 row_newbcast:0 row_mask:0xf bank_mask:0xf
    v_fmac_f32_dpp v105, v196, v234 row_newbcast:1 row_mask:0xf bank_mask:0xf
    v_mfma_f32_16x16x32_bf16 v[144:147], a[140:143], a[16:19], v[144:147]
    buffer_load_dwordx4 v21, s[24:27], s46 offen offset:3072 lds
    v_mfma_f32_16x16x32_bf16 v[144:147], a[136:139], a[144:147], v[144:147]
    s_waitcnt vmcnt(30) lgkmcnt(0)
    s_barrier
    v_mfma_f32_16x16x32_bf16 v[32:35], a[64:67], a[96:99], v[32:35]
    ds_read_b128 a[112:115], v16 offset:18432
    s_add_u32 m0, s43, 32768
    v_mfma_f32_16x16x32_bf16 v[32:35], a[68:71], a[0:3], v[32:35]
    ds_read_b128 a[116:119], v17 offset:18432
    s_lshl_b32 s46, s70, 261
    v_mfma_f32_16x16x32_bf16 v[36:39], a[68:71], a[4:7], v[36:39]
    buffer_load_dwordx4 v18, s[24:27], s46 offen offset:0 lds
    v_mfma_f32_16x16x32_bf16 v[36:39], a[64:67], a[100:103], v[36:39]
    ds_read_b128 a[120:123], v16 offset:26624
    v_fmac_f32_dpp v106, v196, v234 row_newbcast:2 row_mask:0xf bank_mask:0xf
    v_mfma_f32_16x16x32_bf16 v[40:43], a[64:67], a[104:107], v[40:43]
    ds_read_b128 a[124:127], v17 offset:26624
    v_fmac_f32_dpp v107, v196, v234 row_newbcast:3 row_mask:0xf bank_mask:0xf
    v_mfma_f32_16x16x32_bf16 v[40:43], a[68:71], a[8:11], v[40:43]
    ds_read_b128 a[128:131], v16 offset:19456
    v_fmac_f32_dpp v108, v196, v235 row_newbcast:0 row_mask:0xf bank_mask:0xf
    v_mfma_f32_16x16x32_bf16 v[44:47], a[68:71], a[12:15], v[44:47]
    buffer_load_dwordx4 v19, s[24:27], s46 offen offset:1024 lds
    v_mfma_f32_16x16x32_bf16 v[44:47], a[64:67], a[108:111], v[44:47]
    ds_read_b128 a[132:135], v17 offset:19456
    v_fmac_f32_dpp v109, v196, v235 row_newbcast:1 row_mask:0xf bank_mask:0xf
    v_mfma_f32_16x16x32_bf16 v[60:63], a[72:75], a[108:111], v[60:63]
    ds_read_b128 a[136:139], v16 offset:27648
    v_fmac_f32_dpp v110, v196, v235 row_newbcast:2 row_mask:0xf bank_mask:0xf
    v_mfma_f32_16x16x32_bf16 v[60:63], a[76:79], a[12:15], v[60:63]
    ds_read_b128 a[140:143], v17 offset:27648
    v_fmac_f32_dpp v111, v196, v235 row_newbcast:3 row_mask:0xf bank_mask:0xf
    v_mfma_f32_16x16x32_bf16 v[56:59], a[76:79], a[8:11], v[56:59]
    buffer_load_dwordx4 v20, s[24:27], s46 offen offset:2048 lds
    v_mfma_f32_16x16x32_bf16 v[56:59], a[72:75], a[104:107], v[56:59]
    v_fmac_f32_dpp v112, v196, v232 row_newbcast:4 row_mask:0xf bank_mask:0xf
    v_fmac_f32_dpp v113, v196, v232 row_newbcast:5 row_mask:0xf bank_mask:0xf
    v_mfma_f32_16x16x32_bf16 v[52:55], a[72:75], a[100:103], v[52:55]
    v_fmac_f32_dpp v114, v196, v232 row_newbcast:6 row_mask:0xf bank_mask:0xf
    v_fmac_f32_dpp v115, v196, v232 row_newbcast:7 row_mask:0xf bank_mask:0xf
    v_mfma_f32_16x16x32_bf16 v[52:55], a[76:79], a[4:7], v[52:55]
    v_fmac_f32_dpp v116, v196, v233 row_newbcast:4 row_mask:0xf bank_mask:0xf
    v_fmac_f32_dpp v117, v196, v233 row_newbcast:5 row_mask:0xf bank_mask:0xf
    v_mfma_f32_16x16x32_bf16 v[48:51], a[76:79], a[0:3], v[48:51]
    buffer_load_dwordx4 v21, s[24:27], s46 offen offset:3072 lds
    v_mfma_f32_16x16x32_bf16 v[48:51], a[72:75], a[96:99], v[48:51]
    v_fmac_f32_dpp v118, v196, v233 row_newbcast:6 row_mask:0xf bank_mask:0xf
    v_fmac_f32_dpp v119, v196, v233 row_newbcast:7 row_mask:0xf bank_mask:0xf
    v_mfma_f32_16x16x32_bf16 v[64:67], a[80:83], a[96:99], v[64:67]
    s_add_u32 m0, s43, 49152
    v_fmac_f32_dpp v120, v196, v234 row_newbcast:4 row_mask:0xf bank_mask:0xf
    v_fmac_f32_dpp v121, v196, v234 row_newbcast:5 row_mask:0xf bank_mask:0xf
    v_mfma_f32_16x16x32_bf16 v[64:67], a[84:87], a[0:3], v[64:67]
    s_lshl_b32 s46, s71, 261
    v_fmac_f32_dpp v122, v196, v234 row_newbcast:6 row_mask:0xf bank_mask:0xf
    v_fmac_f32_dpp v123, v196, v234 row_newbcast:7 row_mask:0xf bank_mask:0xf
    v_mfma_f32_16x16x32_bf16 v[68:71], a[84:87], a[4:7], v[68:71]
    buffer_load_dwordx4 v18, s[24:27], s46 offen offset:0 lds
    v_mfma_f32_16x16x32_bf16 v[68:71], a[80:83], a[100:103], v[68:71]
    v_fmac_f32_dpp v124, v196, v235 row_newbcast:4 row_mask:0xf bank_mask:0xf
    v_fmac_f32_dpp v125, v196, v235 row_newbcast:5 row_mask:0xf bank_mask:0xf
    v_mfma_f32_16x16x32_bf16 v[72:75], a[80:83], a[104:107], v[72:75]
    v_fmac_f32_dpp v126, v196, v235 row_newbcast:6 row_mask:0xf bank_mask:0xf
    v_fmac_f32_dpp v127, v196, v235 row_newbcast:7 row_mask:0xf bank_mask:0xf
    v_mfma_f32_16x16x32_bf16 v[72:75], a[84:87], a[8:11], v[72:75]
    v_fmac_f32_dpp v128, v196, v232 row_newbcast:8 row_mask:0xf bank_mask:0xf
    v_fmac_f32_dpp v129, v196, v232 row_newbcast:9 row_mask:0xf bank_mask:0xf
    v_mfma_f32_16x16x32_bf16 v[76:79], a[84:87], a[12:15], v[76:79]
    buffer_load_dwordx4 v19, s[24:27], s46 offen offset:1024 lds
    v_mfma_f32_16x16x32_bf16 v[76:79], a[80:83], a[108:111], v[76:79]
    v_fmac_f32_dpp v130, v196, v232 row_newbcast:10 row_mask:0xf bank_mask:0xf
    v_fmac_f32_dpp v131, v196, v232 row_newbcast:11 row_mask:0xf bank_mask:0xf
    v_mfma_f32_16x16x32_bf16 v[92:95], a[88:91], a[108:111], v[92:95]
    v_fmac_f32_dpp v132, v196, v233 row_newbcast:8 row_mask:0xf bank_mask:0xf
    v_fmac_f32_dpp v133, v196, v233 row_newbcast:9 row_mask:0xf bank_mask:0xf
    v_mfma_f32_16x16x32_bf16 v[92:95], a[92:95], a[12:15], v[92:95]
    v_fmac_f32_dpp v134, v196, v233 row_newbcast:10 row_mask:0xf bank_mask:0xf
    v_fmac_f32_dpp v135, v196, v233 row_newbcast:11 row_mask:0xf bank_mask:0xf
    v_mfma_f32_16x16x32_bf16 v[88:91], a[92:95], a[8:11], v[88:91]
    buffer_load_dwordx4 v20, s[24:27], s46 offen offset:2048 lds
    v_mfma_f32_16x16x32_bf16 v[88:91], a[88:91], a[104:107], v[88:91]
    v_fmac_f32_dpp v136, v196, v234 row_newbcast:8 row_mask:0xf bank_mask:0xf
    v_fmac_f32_dpp v137, v196, v234 row_newbcast:9 row_mask:0xf bank_mask:0xf
    v_mfma_f32_16x16x32_bf16 v[84:87], a[88:91], a[100:103], v[84:87]
    v_fmac_f32_dpp v138, v196, v234 row_newbcast:10 row_mask:0xf bank_mask:0xf
    v_fmac_f32_dpp v139, v196, v234 row_newbcast:11 row_mask:0xf bank_mask:0xf
    v_mfma_f32_16x16x32_bf16 v[84:87], a[92:95], a[4:7], v[84:87]
    v_fmac_f32_dpp v140, v196, v235 row_newbcast:8 row_mask:0xf bank_mask:0xf
    v_fmac_f32_dpp v141, v196, v235 row_newbcast:9 row_mask:0xf bank_mask:0xf
    v_mfma_f32_16x16x32_bf16 v[80:83], a[92:95], a[0:3], v[80:83]
    buffer_load_dwordx4 v21, s[24:27], s46 offen offset:3072 lds
    v_mfma_f32_16x16x32_bf16 v[80:83], a[88:91], a[96:99], v[80:83]
    s_waitcnt lgkmcnt(0)
    s_barrier
    v_mfma_f32_16x16x32_bf16 v[96:99], a[112:115], a[96:99], v[96:99]
    v_fmac_f32_dpp v142, v196, v235 row_newbcast:10 row_mask:0xf bank_mask:0xf
    v_fmac_f32_dpp v143, v196, v235 row_newbcast:11 row_mask:0xf bank_mask:0xf
    v_mfma_f32_16x16x32_bf16 v[96:99], a[116:119], a[0:3], v[96:99]
    v_fmac_f32_dpp v144, v196, v232 row_newbcast:12 row_mask:0xf bank_mask:0xf
    v_fmac_f32_dpp v145, v196, v232 row_newbcast:13 row_mask:0xf bank_mask:0xf
    v_mfma_f32_16x16x32_bf16 v[100:103], a[116:119], a[4:7], v[100:103]
    v_fmac_f32_dpp v146, v196, v232 row_newbcast:14 row_mask:0xf bank_mask:0xf
    v_fmac_f32_dpp v147, v196, v232 row_newbcast:15 row_mask:0xf bank_mask:0xf
    v_mfma_f32_16x16x32_bf16 v[100:103], a[112:115], a[100:103], v[100:103]
    v_fmac_f32_dpp v148, v196, v233 row_newbcast:12 row_mask:0xf bank_mask:0xf
    v_fmac_f32_dpp v149, v196, v233 row_newbcast:13 row_mask:0xf bank_mask:0xf
    v_mfma_f32_16x16x32_bf16 v[104:107], a[112:115], a[104:107], v[104:107]
    v_fmac_f32_dpp v150, v196, v233 row_newbcast:14 row_mask:0xf bank_mask:0xf
    v_fmac_f32_dpp v151, v196, v233 row_newbcast:15 row_mask:0xf bank_mask:0xf
    v_mfma_f32_16x16x32_bf16 v[104:107], a[116:119], a[8:11], v[104:107]
    v_fmac_f32_dpp v152, v196, v234 row_newbcast:12 row_mask:0xf bank_mask:0xf
    v_fmac_f32_dpp v153, v196, v234 row_newbcast:13 row_mask:0xf bank_mask:0xf
    v_mfma_f32_16x16x32_bf16 v[108:111], a[116:119], a[12:15], v[108:111]
    v_fmac_f32_dpp v154, v196, v234 row_newbcast:14 row_mask:0xf bank_mask:0xf
    v_fmac_f32_dpp v155, v196, v234 row_newbcast:15 row_mask:0xf bank_mask:0xf
    v_mfma_f32_16x16x32_bf16 v[108:111], a[112:115], a[108:111], v[108:111]
    v_fmac_f32_dpp v156, v196, v235 row_newbcast:12 row_mask:0xf bank_mask:0xf
    v_fmac_f32_dpp v157, v196, v235 row_newbcast:13 row_mask:0xf bank_mask:0xf
    v_mfma_f32_16x16x32_bf16 v[124:127], a[120:123], a[108:111], v[124:127]
    v_fmac_f32_dpp v158, v196, v235 row_newbcast:14 row_mask:0xf bank_mask:0xf
    v_fmac_f32_dpp v159, v196, v235 row_newbcast:15 row_mask:0xf bank_mask:0xf
    v_mfma_f32_16x16x32_bf16 v[124:127], a[124:127], a[12:15], v[124:127]
    v_mul_f32_dpp v32, v194, v32 row_newbcast:0 row_mask:0xf bank_mask:0xf
    v_mul_f32_dpp v33, v194, v33 row_newbcast:1 row_mask:0xf bank_mask:0xf
    v_mfma_f32_16x16x32_bf16 v[120:123], a[124:127], a[8:11], v[120:123]
    v_mul_f32_dpp v34, v194, v34 row_newbcast:2 row_mask:0xf bank_mask:0xf
    v_mul_f32_dpp v35, v194, v35 row_newbcast:3 row_mask:0xf bank_mask:0xf
    v_mfma_f32_16x16x32_bf16 v[120:123], a[120:123], a[104:107], v[120:123]
    v_mul_f32_dpp v48, v194, v48 row_newbcast:4 row_mask:0xf bank_mask:0xf
    v_mul_f32_dpp v49, v194, v49 row_newbcast:5 row_mask:0xf bank_mask:0xf
    v_mfma_f32_16x16x32_bf16 v[116:119], a[120:123], a[100:103], v[116:119]
    v_mul_f32_dpp v50, v194, v50 row_newbcast:6 row_mask:0xf bank_mask:0xf
    v_mul_f32_dpp v51, v194, v51 row_newbcast:7 row_mask:0xf bank_mask:0xf
    v_mfma_f32_16x16x32_bf16 v[116:119], a[124:127], a[4:7], v[116:119]
    v_mul_f32_dpp v64, v194, v64 row_newbcast:8 row_mask:0xf bank_mask:0xf
    v_mul_f32_dpp v65, v194, v65 row_newbcast:9 row_mask:0xf bank_mask:0xf
    v_mfma_f32_16x16x32_bf16 v[112:115], a[124:127], a[0:3], v[112:115]
    v_mul_f32_dpp v66, v194, v66 row_newbcast:10 row_mask:0xf bank_mask:0xf
    v_mul_f32_dpp v67, v194, v67 row_newbcast:11 row_mask:0xf bank_mask:0xf
    v_mfma_f32_16x16x32_bf16 v[112:115], a[120:123], a[96:99], v[112:115]
    v_mul_f32_dpp v80, v194, v80 row_newbcast:12 row_mask:0xf bank_mask:0xf
    v_mul_f32_dpp v81, v194, v81 row_newbcast:13 row_mask:0xf bank_mask:0xf
    v_mfma_f32_16x16x32_bf16 v[128:131], a[128:131], a[96:99], v[128:131]
    s_add_u32 m0, s43, 65536
    v_mul_f32_dpp v82, v194, v82 row_newbcast:14 row_mask:0xf bank_mask:0xf
    v_mul_f32_dpp v83, v194, v83 row_newbcast:15 row_mask:0xf bank_mask:0xf
    v_mfma_f32_16x16x32_bf16 v[128:131], a[132:135], a[0:3], v[128:131]
    s_lshl_b32 s46, s72, 261
    v_mul_f32_dpp v40, v194, v40 row_newbcast:0 row_mask:0xf bank_mask:0xf
    v_mul_f32_dpp v41, v194, v41 row_newbcast:1 row_mask:0xf bank_mask:0xf
    v_mfma_f32_16x16x32_bf16 v[132:135], a[132:135], a[4:7], v[132:135]
    buffer_load_dwordx4 v18, s[24:27], s46 offen offset:0 lds
    v_mfma_f32_16x16x32_bf16 v[132:135], a[128:131], a[100:103], v[132:135]
    v_mul_f32_dpp v42, v194, v42 row_newbcast:2 row_mask:0xf bank_mask:0xf
    v_mul_f32_dpp v43, v194, v43 row_newbcast:3 row_mask:0xf bank_mask:0xf
    v_mfma_f32_16x16x32_bf16 v[136:139], a[128:131], a[104:107], v[136:139]
    v_mul_f32_dpp v56, v194, v56 row_newbcast:4 row_mask:0xf bank_mask:0xf
    v_mul_f32_dpp v57, v194, v57 row_newbcast:5 row_mask:0xf bank_mask:0xf
    v_mfma_f32_16x16x32_bf16 v[136:139], a[132:135], a[8:11], v[136:139]
    v_mul_f32_dpp v58, v194, v58 row_newbcast:6 row_mask:0xf bank_mask:0xf
    v_mul_f32_dpp v59, v194, v59 row_newbcast:7 row_mask:0xf bank_mask:0xf
    v_mfma_f32_16x16x32_bf16 v[140:143], a[132:135], a[12:15], v[140:143]
    buffer_load_dwordx4 v19, s[24:27], s46 offen offset:1024 lds
    v_mfma_f32_16x16x32_bf16 v[140:143], a[128:131], a[108:111], v[140:143]
    v_mul_f32_dpp v72, v194, v72 row_newbcast:8 row_mask:0xf bank_mask:0xf
    v_mul_f32_dpp v73, v194, v73 row_newbcast:9 row_mask:0xf bank_mask:0xf
    v_mfma_f32_16x16x32_bf16 v[156:159], a[136:139], a[108:111], v[156:159]
    v_mul_f32_dpp v74, v194, v74 row_newbcast:10 row_mask:0xf bank_mask:0xf
    v_mul_f32_dpp v75, v194, v75 row_newbcast:11 row_mask:0xf bank_mask:0xf
    v_mfma_f32_16x16x32_bf16 v[156:159], a[140:143], a[12:15], v[156:159]
    v_mul_f32_dpp v88, v194, v88 row_newbcast:12 row_mask:0xf bank_mask:0xf
    v_mul_f32_dpp v89, v194, v89 row_newbcast:13 row_mask:0xf bank_mask:0xf
    v_mfma_f32_16x16x32_bf16 v[152:155], a[140:143], a[8:11], v[152:155]
    buffer_load_dwordx4 v20, s[24:27], s46 offen offset:2048 lds
k_pad11:
    s_cbranch_execz k_padback
    s_nop 0
    v_mfma_f32_16x16x32_bf16 v[152:155], a[136:139], a[104:107], v[152:155]
    v_mul_f32_dpp v90, v194, v90 row_newbcast:14 row_mask:0xf bank_mask:0xf
    v_mul_f32_dpp v91, v194, v91 row_newbcast:15 row_mask:0xf bank_mask:0xf
    v_mfma_f32_16x16x32_bf16 v[148:151], a[136:139], a[100:103], v[148:151]
    v_mul_f32_dpp v36, v194, v36 row_newbcast:0 row_mask:0xf bank_mask:0xf
    v_mul_f32_dpp v37, v194, v37 row_newbcast:1 row_mask:0xf bank_mask:0xf
    v_mfma_f32_16x16x32_bf16 v[148:151], a[140:143], a[4:7], v[148:151]
    v_mul_f32_dpp v38, v194, v38 row_newbcast:2 row_mask:0xf bank_mask:0xf
    v_mul_f32_dpp v39, v194, v39 row_newbcast:3 row_mask:0xf bank_mask:0xf
    v_mfma_f32_16x16x32_bf16 v[144:147], a[140:143], a[0:3], v[144:147]
    buffer_load_dwordx4 v21, s[24:27], s46 offen offset:3072 lds
    v_mfma_f32_16x16x32_bf16 v[144:147], a[136:139], a[96:99], v[144:147]
    v_mul_f32_dpp v52, v194, v52 row_newbcast:4 row_mask:0xf bank_mask:0xf
    v_mul_f32_dpp v53, v194, v53 row_newbcast:5 row_mask:0xf bank_mask:0xf
k_depi:
    s_waitcnt lgkmcnt(0)
    s_waitcnt vmcnt(20)
    ds_read_b64_tr_b16 a[0:1], v22 offset:16384
    ds_read_b64_tr_b16 a[2:3], v22 offset:18432
    ds_read_b64_tr_b16 a[4:5], v23 offset:16384
    ds_read_b64_tr_b16 a[6:7], v23 offset:18432
    ds_read_b64_tr_b16 a[8:9], v24 offset:16384
    ds_read_b64_tr_b16 a[10:11], v24 offset:18432
    ds_read_b64_tr_b16 a[12:13], v25 offset:16384
    ds_read_b64_tr_b16 a[14:15], v25 offset:18432
    s_cmp_eq_u32 s36, 0
    s_cselect_b32 s5, 0, s4
    s_cselect_b32 s6, s4, 0
    v_cvt_pk_bf16_f32 v160, v32, v33
    v_cvt_pk_bf16_f32 v164, v40, v41
    v_cvt_pk_bf16_f32 v161, v34, v35
    s_waitcnt lgkmcnt(0)
    s_add_u32 m0, s43, 114688
    s_lshl_b32 s46, s73, 261
    buffer_load_dwordx4 v18, s[24:27], s46 offen offset:0 lds
    v_mfma_f32_16x16x32_bf16 v[4:7], v[224:227], a[224:227], 0
    ds_read_b64_tr_b16 a[16:17], v22 offset:32768
    v_cvt_pk_bf16_f32 v165, v42, v43
    v_cvt_pk_bf16_f32 v162, v48, v49
    v_cvt_pk_bf16_f32 v166, v56, v57
    v_mfma_f32_16x16x32_bf16 v[240:243], v[224:227], a[228:231], 0
    ds_read_b64_tr_b16 a[18:19], v22 offset:34816
    v_cvt_pk_bf16_f32 v163, v50, v51
    buffer_load_dwordx4 v19, s[24:27], s46 offen offset:1024 lds
    v_cvt_pk_bf16_f32 v167, v58, v59
    v_xor_b32_e64 v172, s5, v160
    v_mfma_f32_16x16x32_bf16 v[4:7], v[228:231], a[232:235], v[4:7]
    ds_read_b64_tr_b16 a[20:21], v23 offset:32768
    v_xor_b32 v173, s5, v161
    v_xor_b32 v174, s5, v162
    v_xor_b32_e64 v175, s5, v163
    buffer_load_dwordx4 v20, s[24:27], s46 offen offset:2048 lds
    v_mfma_f32_16x16x32_bf16 v[240:243], v[200:203], a[236:239], v[240:243]
    ds_read_b64_tr_b16 a[22:23], v23 offset:34816
    v_mfma_f32_16x16x32_bf16 v[32:35], a[160:163], v[160:163], 0
    ds_read_b64_tr_b16 a[24:25], v24 offset:32768
    v_mul_f32_dpp v128, v198, v128 row_newbcast:8 row_mask:0xf bank_mask:0xf
    v_mul_f32_dpp v129, v198, v129 row_newbcast:9 row_mask:0xf bank_mask:0xf
    v_mul_f32_dpp v130, v198, v130 row_newbcast:10 row_mask:0xf bank_mask:0xf
    v_mul_f32_dpp v131, v198, v131 row_newbcast:11 row_mask:0xf bank_mask:0xf
    buffer_load_dwordx4 v21, s[24:27], s46 offen offset:3072 lds
    v_mfma_f32_16x16x32_bf16 v[40:43], a[240:243], v[164:167], 0
    ds_read_b64_tr_b16 a[26:27], v24 offset:34816
    v_mul_f32_dpp v136, v198, v136 row_newbcast:8 row_mask:0xf bank_mask:0xf
    v_mul_f32_dpp v137, v198, v137 row_newbcast:9 row_mask:0xf bank_mask:0xf
    v_mul_f32_dpp v138, v198, v138 row_newbcast:10 row_mask:0xf bank_mask:0xf
    v_mul_f32_dpp v139, v198, v139 row_newbcast:11 row_mask:0xf bank_mask:0xf
    v_mfma_f32_16x16x32_bf16 v[48:51], a[168:171], v[160:163], 0
    ds_read_b64_tr_b16 a[28:29], v25 offset:32768
    v_mul_f32_dpp v144, v198, v144 row_newbcast:12 row_mask:0xf bank_mask:0xf
    v_mul_f32_dpp v145, v198, v145 row_newbcast:13 row_mask:0xf bank_mask:0xf
    v_mul_f32_dpp v146, v198, v146 row_newbcast:14 row_mask:0xf bank_mask:0xf
    v_mul_f32_dpp v147, v198, v147 row_newbcast:15 row_mask:0xf bank_mask:0xf
    v_mfma_f32_16x16x32_bf16 v[56:59], a[248:251], v[164:167], 0
    ds_read_b64_tr_b16 a[30:31], v25 offset:34816
    v_mul_f32_dpp v152, v198, v152 row_newbcast:12 row_mask:0xf bank_mask:0xf
    s_waitcnt lgkmcnt(0)
    s_add_u32 m0, s43, 131072
    s_lshl_b32 s46, s74, 5
    buffer_load_dwordx4 v18, s[24:27], s46 offen offset:0 lds
    v_mul_f32_dpp v153, v198, v153 row_newbcast:13 row_mask:0xf bank_mask:0xf
    v_mul_f32_dpp v154, v198, v154 row_newbcast:14 row_mask:0xf bank_mask:0xf
    v_mul_f32_dpp v155, v198, v155 row_newbcast:15 row_mask:0xf bank_mask:0xf
    v_mfma_f32_16x16x32_bf16 v[32:35], a[164:167], v[164:167], v[32:35]
    ds_read_b64_tr_b16 a[32:33], v22 offset:0
    v_cvt_pk_bf16_f32 v176, v128, v129
    v_cvt_pk_bf16_f32 v180, v136, v137
    buffer_load_dwordx4 v19, s[24:27], s46 offen offset:1024 lds
    v_cvt_pk_bf16_f32 v177, v130, v131
    v_cvt_pk_bf16_f32 v181, v138, v139
    v_mfma_f32_16x16x32_bf16 v[40:43], a[244:247], v[172:175], v[40:43]
    ds_read_b64_tr_b16 a[34:35], v22 offset:2048
    v_cvt_pk_bf16_f32 v178, v144, v145
    v_cvt_pk_bf16_f32 v182, v152, v153
    v_cvt_pk_bf16_f32 v179, v146, v147
    buffer_load_dwordx4 v20, s[24:27], s46 offen offset:2048 lds
    v_cvt_pk_bf16_f32 v183, v154, v155
    v_mfma_f32_16x16x32_bf16 v[48:51], a[172:175], v[164:167], v[48:51]
    ds_read_b64_tr_b16 a[36:37], v23 offset:0
    v_xor_b32 v184, s4, v180
    v_xor_b32 v188, s6, v176
    v_xor_b32 v185, s4, v181
    v_xor_b32 v189, s6, v177
    buffer_load_dwordx4 v21, s[24:27], s46 offen offset:3072 lds
    v_mfma_f32_16x16x32_bf16 v[56:59], a[252:255], v[172:175], v[56:59]
    ds_read_b64_tr_b16 a[38:39], v23 offset:2048
    v_xor_b32 v186, s4, v182
    v_xor_b32 v190, s6, v178
    v_xor_b32 v187, s4, v183
    v_xor_b32 v191, s6, v179
    v_mfma_f32_16x16x32_bf16 v[32:35], a[208:211], v[176:179], v[32:35]
    ds_read_b64_tr_b16 a[40:41], v24 offset:0
    v_cvt_pk_bf16_f32 v4, v4, v240
    s_add_u32 m0, s43, 81920
    s_lshl_b32 s46, s75, 5
    buffer_load_dwordx4 v18, s[24:27], s46 offen offset:0 lds
    v_xor_b32 v4, s56, v4
    v_mfma_f32_16x16x32_bf16 v[40:43], v[212:215], v[184:187], v[40:43]
    ds_read_b64_tr_b16 a[42:43], v24 offset:2048
    v_cvt_pk_bf16_f32 v160, v64, v65
    v_cvt_pk_bf16_f32 v164, v72, v73
    v_mfma_f32_16x16x32_bf16 v[48:51], a[216:219], v[176:179], v[48:51]
    ds_read_b64_tr_b16 a[44:45], v25 offset:0
    v_cvt_pk_bf16_f32 v161, v66, v67
    buffer_load_dwordx4 v19, s[24:27], s46 offen offset:1024 lds
    v_cvt_pk_bf16_f32 v165, v74, v75
    v_mfma_f32_16x16x32_bf16 v[56:59], v[244:247], v[184:187], v[56:59]
    ds_read_b64_tr_b16 a[46:47], v25 offset:2048
    v_cvt_pk_bf16_f32 v162, v80, v81
    v_cvt_pk_bf16_f32 v166, v88, v89
    v_mfma_f32_16x16x32_bf16 v[32:35], a[212:215], v[180:183], v[32:35]
    ds_read_b64_tr_b16 a[48:49], v22 offset:49152
    v_cvt_pk_bf16_f32 v163, v82, v83
    buffer_load_dwordx4 v20, s[24:27], s46 offen offset:2048 lds
    v_cvt_pk_bf16_f32 v167, v90, v91
    v_mfma_f32_16x16x32_bf16 v[40:43], v[216:219], v[188:191], v[40:43]
    ds_read_b64_tr_b16 a[50:51], v22 offset:51200
    v_xor_b32 v172, s4, v160
    v_xor_b32 v173, s4, v161
    v_mfma_f32_16x16x32_bf16 v[48:51], a[220:223], v[180:183], v[48:51]
    ds_read_b64_tr_b16 a[52:53], v23 offset:49152
    v_xor_b32 v174, s4, v162
    buffer_load_dwordx4 v21, s[24:27], s46 offen offset:3072 lds
    v_xor_b32 v175, s4, v163
    v_mfma_f32_16x16x32_bf16 v[56:59], v[248:251], v[188:191], v[56:59]
    ds_read_b64_tr_b16 a[54:55], v23 offset:51200
    v_mfma_f32_16x16x32_bf16 v[64:67], a[176:179], v[160:163], 0
    ds_read_b64_tr_b16 a[56:57], v24 offset:49152
    v_mul_f32_dpp v96, v198, v96 row_newbcast:0 row_mask:0xf bank_mask:0xf
    v_mul_f32_dpp v97, v198, v97 row_newbcast:1 row_mask:0xf bank_mask:0xf
    v_mul_f32_dpp v98, v198, v98 row_newbcast:2 row_mask:0xf bank_mask:0xf
    s_waitcnt lgkmcnt(5)
    s_add_u32 m0, s43, 98304
    s_lshl_b32 s46, s76, 5
    buffer_load_dwordx4 v18, s[24:27], s46 offen offset:0 lds
    v_mul_f32_dpp v99, v198, v99 row_newbcast:3 row_mask:0xf bank_mask:0xf
    v_mfma_f32_16x16x32_bf16 v[72:75], a[176:179], v[164:167], 0
    ds_read_b64_tr_b16 a[58:59], v24 offset:51200
    v_mul_f32_dpp v104, v198, v104 row_newbcast:0 row_mask:0xf bank_mask:0xf
    v_mul_f32_dpp v105, v198, v105 row_newbcast:1 row_mask:0xf bank_mask:0xf
    v_mul_f32_dpp v106, v198, v106 row_newbcast:2 row_mask:0xf bank_mask:0xf
    v_mul_f32_dpp v107, v198, v107 row_newbcast:3 row_mask:0xf bank_mask:0xf
    buffer_load_dwordx4 v19, s[24:27], s46 offen offset:1024 lds
    v_mfma_f32_16x16x32_bf16 v[80:83], a[184:187], v[160:163], 0
    ds_read_b64_tr_b16 a[60:61], v25 offset:49152
    v_mul_f32_dpp v112, v198, v112 row_newbcast:4 row_mask:0xf bank_mask:0xf
    v_mul_f32_dpp v113, v198, v113 row_newbcast:5 row_mask:0xf bank_mask:0xf
    v_mul_f32_dpp v114, v198, v114 row_newbcast:6 row_mask:0xf bank_mask:0xf
    v_mul_f32_dpp v115, v198, v115 row_newbcast:7 row_mask:0xf bank_mask:0xf
    v_mfma_f32_16x16x32_bf16 v[88:91], a[184:187], v[164:167], 0
    ds_read_b64_tr_b16 a[62:63], v25 offset:51200
    v_mul_f32_dpp v120, v198, v120 row_newbcast:4 row_mask:0xf bank_mask:0xf
    buffer_load_dwordx4 v20, s[24:27], s46 offen offset:2048 lds
    v_mul_f32_dpp v121, v198, v121 row_newbcast:5 row_mask:0xf bank_mask:0xf
    v_mul_f32_dpp v122, v198, v122 row_newbcast:6 row_mask:0xf bank_mask:0xf
    v_mul_f32_dpp v123, v198, v123 row_newbcast:7 row_mask:0xf bank_mask:0xf
    v_mfma_f32_16x16x32_bf16 v[64:67], a[180:183], v[164:167], v[64:67]
    v_cvt_pk_bf16_f32 v176, v96, v97
    v_cvt_pk_bf16_f32 v180, v104, v105
    buffer_load_dwordx4 v21, s[24:27], s46 offen offset:3072 lds
    v_cvt_pk_bf16_f32 v177, v98, v99
    v_cvt_pk_bf16_f32 v181, v106, v107
    v_mfma_f32_16x16x32_bf16 v[72:75], a[180:183], v[172:175], v[72:75]
    v_cvt_pk_bf16_f32 v178, v112, v113
    v_cvt_pk_bf16_f32 v182, v120, v121
    v_cvt_pk_bf16_f32 v179, v114, v115
    s_waitcnt lgkmcnt(0)
    s_add_u32 m0, s43, 147456
    s_lshl_b32 s46, s77, 5
    buffer_load_dwordx4 v18, s[24:27], s46 offen offset:0 lds
    v_cvt_pk_bf16_f32 v183, v122, v123
    v_mfma_f32_16x16x32_bf16 v[80:83], a[188:191], v[164:167], v[80:83]
    v_xor_b32 v184, s4, v180
    v_xor_b32 v185, s4, v181
    v_xor_b32 v186, s4, v182
    v_xor_b32 v187, s4, v183
    buffer_load_dwordx4 v19, s[24:27], s46 offen offset:1024 lds
    v_mfma_f32_16x16x32_bf16 v[88:91], a[188:191], v[172:175], v[88:91]
    v_mfma_f32_16x16x32_bf16 v[64:67], a[192:195], v[176:179], v[64:67]
    v_mul_f32_dpp v44, v194, v44 row_newbcast:0 row_mask:0xf bank_mask:0xf
    v_mul_f32_dpp v45, v194, v45 row_newbcast:1 row_mask:0xf bank_mask:0xf
    v_mul_f32_dpp v46, v194, v46 row_newbcast:2 row_mask:0xf bank_mask:0xf
    v_mfma_f32_16x16x32_bf16 v[72:75], a[192:195], v[184:187], v[72:75]
    buffer_load_dwordx4 v20, s[24:27], s46 offen offset:2048 lds
    v_mul_f32_dpp v47, v194, v47 row_newbcast:3 row_mask:0xf bank_mask:0xf
    v_mul_f32_dpp v54, v194, v54 row_newbcast:6 row_mask:0xf bank_mask:0xf
    v_mul_f32_dpp v55, v194, v55 row_newbcast:7 row_mask:0xf bank_mask:0xf
    v_mfma_f32_16x16x32_bf16 v[80:83], a[200:203], v[176:179], v[80:83]
    v_mul_f32_dpp v60, v194, v60 row_newbcast:4 row_mask:0xf bank_mask:0xf
    v_mul_f32_dpp v61, v194, v61 row_newbcast:5 row_mask:0xf bank_mask:0xf
    buffer_load_dwordx4 v21, s[24:27], s46 offen offset:3072 lds
    v_mul_f32_dpp v62, v194, v62 row_newbcast:6 row_mask:0xf bank_mask:0xf
    v_mfma_f32_16x16x32_bf16 v[88:91], a[200:203], v[184:187], v[88:91]
    v_mul_f32_dpp v63, v194, v63 row_newbcast:7 row_mask:0xf bank_mask:0xf
    v_cvt_pk_bf16_f32 v160, v36, v37
    v_cvt_pk_bf16_f32 v164, v44, v45
    v_mfma_f32_16x16x32_bf16 v[64:67], a[196:199], v[180:183], v[64:67]
    v_cvt_pk_bf16_f32 v161, v38, v39
    v_cvt_pk_bf16_f32 v165, v46, v47
    v_cvt_pk_bf16_f32 v162, v52, v53
    v_mfma_f32_16x16x32_bf16 v[72:75], a[196:199], v[176:179], v[72:75]
    v_cvt_pk_bf16_f32 v166, v60, v61
    v_cvt_pk_bf16_f32 v163, v54, v55
    v_cvt_pk_bf16_f32 v167, v62, v63
    v_mfma_f32_16x16x32_bf16 v[80:83], a[204:207], v[180:183], v[80:83]
    v_xor_b32 v172, s5, v160
    v_xor_b32 v173, s5, v161
    v_xor_b32 v174, s5, v162
    v_mfma_f32_16x16x32_bf16 v[88:91], a[204:207], v[176:179], v[88:91]
    v_xor_b32 v175, s5, v163
    v_mfma_f32_16x16x32_bf16 v[36:39], a[160:163], v[160:163], 0
    v_mul_f32_dpp v132, v198, v132 row_newbcast:8 row_mask:0xf bank_mask:0xf
    v_mul_f32_dpp v133, v198, v133 row_newbcast:9 row_mask:0xf bank_mask:0xf
    v_mul_f32_dpp v134, v198, v134 row_newbcast:10 row_mask:0xf bank_mask:0xf
    v_mul_f32_dpp v135, v198, v135 row_newbcast:11 row_mask:0xf bank_mask:0xf
    v_mul_f32_dpp v140, v198, v140 row_newbcast:8 row_mask:0xf bank_mask:0xf
    v_mul_f32_dpp v141, v198, v141 row_newbcast:9 row_mask:0xf bank_mask:0xf
    v_mfma_f32_16x16x32_bf16 v[44:47], a[240:243], v[164:167], 0
    v_mul_f32_dpp v142, v198, v142 row_newbcast:10 row_mask:0xf bank_mask:0xf
    v_mul_f32_dpp v143, v198, v143 row_newbcast:11 row_mask:0xf bank_mask:0xf
    v_mul_f32_dpp v148, v198, v148 row_newbcast:12 row_mask:0xf bank_mask:0xf
    v_mul_f32_dpp v149, v198, v149 row_newbcast:13 row_mask:0xf bank_mask:0xf
    v_mul_f32_dpp v150, v198, v150 row_newbcast:14 row_mask:0xf bank_mask:0xf
    v_mul_f32_dpp v151, v198, v151 row_newbcast:15 row_mask:0xf bank_mask:0xf
    v_mfma_f32_16x16x32_bf16 v[52:55], a[168:171], v[160:163], 0
    v_mul_f32_dpp v156, v198, v156 row_newbcast:12 row_mask:0xf bank_mask:0xf
    v_mul_f32_dpp v157, v198, v157 row_newbcast:13 row_mask:0xf bank_mask:0xf
    v_mul_f32_dpp v158, v198, v158 row_newbcast:14 row_mask:0xf bank_mask:0xf
    v_mul_f32_dpp v159, v198, v159 row_newbcast:15 row_mask:0xf bank_mask:0xf
    v_cvt_pk_bf16_f32 v176, v132, v133
    v_cvt_pk_bf16_f32 v180, v140, v141
    v_mfma_f32_16x16x32_bf16 v[60:63], a[248:251], v[164:167], 0
    v_cvt_pk_bf16_f32 v177, v134, v135
    v_cvt_pk_bf16_f32 v181, v142, v143
    v_cvt_pk_bf16_f32 v178, v148, v149
    v_cvt_pk_bf16_f32 v182, v156, v157
    v_cvt_pk_bf16_f32 v179, v150, v151
    v_cvt_pk_bf16_f32 v183, v158, v159
    v_mfma_f32_16x16x32_bf16 v[36:39], a[164:167], v[164:167], v[36:39]
    v_xor_b32 v184, s4, v180
    v_xor_b32 v188, s6, v176
    v_xor_b32 v185, s4, v181
    v_xor_b32 v189, s6, v177
    v_xor_b32 v186, s4, v182
    v_xor_b32 v190, s6, v178
    v_mfma_f32_16x16x32_bf16 v[44:47], a[244:247], v[172:175], v[44:47]
    v_xor_b32 v187, s4, v183
    v_xor_b32_e64 v191, s6, v179
    s_waitcnt vmcnt(24)
    buffer_store_dword v4, v2, s[20:23], s52 offen sc1
    v_cvt_pk_bf16_f32 v204, v32, v40
    v_cvt_pk_bf16_f32 v205, v64, v72
    s_add_u32 s53, s51, 0
    s_nop 0
    v_mfma_f32_16x16x32_bf16 v[52:55], a[172:175], v[164:167], v[52:55]
    buffer_store_dwordx2 v[204:205], v3, s[20:23], s53 offen offset:0 sc1
    v_cvt_pk_bf16_f32 v206, v33, v41
    v_cvt_pk_bf16_f32 v207, v65, v73
    s_add_u32 s53, s51, 34816
    buffer_store_dwordx2 v[206:207], v3, s[20:23], s53 offen offset:0 sc1
    v_mfma_f32_16x16x32_bf16 v[60:63], a[252:255], v[172:175], v[60:63]
    v_mfma_f32_16x16x32_bf16 v[36:39], a[208:211], v[176:179], v[36:39]
    v_mul_f32_dpp v68, v194, v68 row_newbcast:8 row_mask:0xf bank_mask:0xf
    v_mul_f32_dpp v69, v194, v69 row_newbcast:9 row_mask:0xf bank_mask:0xf
    v_mul_f32_dpp v70, v194, v70 row_newbcast:10 row_mask:0xf bank_mask:0xf
    v_mul_f32_dpp v71, v194, v71 row_newbcast:11 row_mask:0xf bank_mask:0xf
    v_mul_f32_dpp v76, v194, v76 row_newbcast:8 row_mask:0xf bank_mask:0xf
    v_mfma_f32_16x16x32_bf16 v[44:47], v[212:215], v[184:187], v[44:47]
    v_mul_f32_dpp v77, v194, v77 row_newbcast:9 row_mask:0xf bank_mask:0xf
    v_mul_f32_dpp v78, v194, v78 row_newbcast:10 row_mask:0xf bank_mask:0xf
    v_mul_f32_dpp v79, v194, v79 row_newbcast:11 row_mask:0xf bank_mask:0xf
    v_mul_f32_dpp v84, v194, v84 row_newbcast:12 row_mask:0xf bank_mask:0xf
    v_mul_f32_dpp v85, v194, v85 row_newbcast:13 row_mask:0xf bank_mask:0xf
    v_mfma_f32_16x16x32_bf16 v[52:55], a[216:219], v[176:179], v[52:55]
    v_mul_f32_dpp v86, v194, v86 row_newbcast:14 row_mask:0xf bank_mask:0xf
    v_mul_f32_dpp v87, v194, v87 row_newbcast:15 row_mask:0xf bank_mask:0xf
    v_mul_f32_dpp v92, v194, v92 row_newbcast:12 row_mask:0xf bank_mask:0xf
    v_mul_f32_dpp v93, v194, v93 row_newbcast:13 row_mask:0xf bank_mask:0xf
    v_mul_f32_dpp v94, v194, v94 row_newbcast:14 row_mask:0xf bank_mask:0xf
    v_mfma_f32_16x16x32_bf16 v[60:63], v[244:247], v[184:187], v[60:63]
    v_mul_f32_dpp v95, v194, v95 row_newbcast:15 row_mask:0xf bank_mask:0xf
    v_cvt_pk_bf16_f32 v160, v68, v69
    v_cvt_pk_bf16_f32 v164, v76, v77
    v_cvt_pk_bf16_f32 v161, v70, v71
    v_cvt_pk_bf16_f32 v165, v78, v79
    v_mfma_f32_16x16x32_bf16 v[36:39], a[212:215], v[180:183], v[36:39]
    v_cvt_pk_bf16_f32 v162, v84, v85
    v_cvt_pk_bf16_f32 v166, v92, v93
    v_cvt_pk_bf16_f32 v163, v86, v87
    v_cvt_pk_bf16_f32 v167, v94, v95
    v_xor_b32 v172, s4, v160
    v_mfma_f32_16x16x32_bf16 v[44:47], v[216:219], v[188:191], v[44:47]
    v_xor_b32 v173, s4, v161
    v_xor_b32 v174, s4, v162
    v_xor_b32 v175, s4, v163
    v_cvt_pk_bf16_f32 v208, v34, v42
    v_cvt_pk_bf16_f32 v209, v66, v74
    v_mfma_f32_16x16x32_bf16 v[52:55], a[220:223], v[180:183], v[52:55]
    s_add_u32 s53, s51, 69632
    buffer_store_dwordx2 v[208:209], v3, s[20:23], s53 offen offset:0 sc1
    v_cvt_pk_bf16_f32 v210, v35, v43
    v_cvt_pk_bf16_f32 v211, v67, v75
    s_add_u32 s53, s51, 104448
    v_mfma_f32_16x16x32_bf16 v[60:63], v[248:251], v[188:191], v[60:63]
    buffer_store_dwordx2 v[210:211], v3, s[20:23], s53 offen offset:0 sc1
    v_mfma_f32_16x16x32_bf16 v[68:71], a[176:179], v[160:163], 0
    v_mul_f32_dpp v100, v198, v100 row_newbcast:0 row_mask:0xf bank_mask:0xf
    v_mul_f32_dpp v101, v198, v101 row_newbcast:1 row_mask:0xf bank_mask:0xf
    v_mul_f32_dpp v102, v198, v102 row_newbcast:2 row_mask:0xf bank_mask:0xf
    v_mul_f32_dpp v103, v198, v103 row_newbcast:3 row_mask:0xf bank_mask:0xf
    v_mul_f32_dpp v108, v198, v108 row_newbcast:0 row_mask:0xf bank_mask:0xf
    v_mfma_f32_16x16x32_bf16 v[76:79], a[176:179], v[164:167], 0
    v_mul_f32_dpp v109, v198, v109 row_newbcast:1 row_mask:0xf bank_mask:0xf
    v_mul_f32_dpp v110, v198, v110 row_newbcast:2 row_mask:0xf bank_mask:0xf
    v_mul_f32_dpp v111, v198, v111 row_newbcast:3 row_mask:0xf bank_mask:0xf
    v_mul_f32_dpp v116, v198, v116 row_newbcast:4 row_mask:0xf bank_mask:0xf
    v_mul_f32_dpp v117, v198, v117 row_newbcast:5 row_mask:0xf bank_mask:0xf
    v_mfma_f32_16x16x32_bf16 v[84:87], a[184:187], v[160:163], 0
    v_mul_f32_dpp v118, v198, v118 row_newbcast:6 row_mask:0xf bank_mask:0xf
    v_mul_f32_dpp v119, v198, v119 row_newbcast:7 row_mask:0xf bank_mask:0xf
    v_mul_f32_dpp v124, v198, v124 row_newbcast:4 row_mask:0xf bank_mask:0xf
    v_mul_f32_dpp v125, v198, v125 row_newbcast:5 row_mask:0xf bank_mask:0xf
    v_mul_f32_dpp v126, v198, v126 row_newbcast:6 row_mask:0xf bank_mask:0xf
    v_mfma_f32_16x16x32_bf16 v[92:95], a[184:187], v[164:167], 0
    v_mul_f32_dpp v127, v198, v127 row_newbcast:7 row_mask:0xf bank_mask:0xf
    v_cvt_pk_bf16_f32 v176, v100, v101
    v_cvt_pk_bf16_f32 v180, v108, v109
    v_cvt_pk_bf16_f32 v177, v102, v103
    v_cvt_pk_bf16_f32 v181, v110, v111
    v_mfma_f32_16x16x32_bf16 v[68:71], a[180:183], v[164:167], v[68:71]
    v_cvt_pk_bf16_f32 v178, v116, v117
    v_cvt_pk_bf16_f32 v182, v124, v125
    v_cvt_pk_bf16_f32 v179, v118, v119
    v_cvt_pk_bf16_f32 v183, v126, v127
    v_xor_b32 v184, s4, v180
    v_mfma_f32_16x16x32_bf16 v[76:79], a[180:183], v[172:175], v[76:79]
    v_xor_b32 v185, s4, v181
    v_xor_b32 v186, s4, v182
    v_xor_b32 v187, s4, v183
    v_cvt_pk_bf16_f32 v236, v48, v56
    v_cvt_pk_bf16_f32 v237, v80, v88
    v_mfma_f32_16x16x32_bf16 v[84:87], a[188:191], v[164:167], v[84:87]
    s_add_u32 s53, s51, 557056
    buffer_store_dwordx2 v[236:237], v3, s[20:23], s53 offen offset:0 sc1
    v_cvt_pk_bf16_f32 v238, v49, v57
    v_cvt_pk_bf16_f32 v239, v81, v89
    s_add_u32 s53, s51, 591872
    v_mfma_f32_16x16x32_bf16 v[92:95], a[188:191], v[172:175], v[92:95]
    buffer_store_dwordx2 v[238:239], v3, s[20:23], s53 offen offset:0 sc1
    v_mfma_f32_16x16x32_bf16 v[68:71], a[192:195], v[176:179], v[68:71]
    v_cvt_pk_bf16_f32 v204, v50, v58
    v_mfma_f32_16x16x32_bf16 v[76:79], a[192:195], v[184:187], v[76:79]
    v_cvt_pk_bf16_f32 v205, v82, v90
    v_mfma_f32_16x16x32_bf16 v[84:87], a[200:203], v[176:179], v[84:87]
    s_add_u32 s53, s51, 626688
    v_mfma_f32_16x16x32_bf16 v[92:95], a[200:203], v[184:187], v[92:95]
    buffer_store_dwordx2 v[204:205], v3, s[20:23], s53 offen offset:0 sc1
    v_mfma_f32_16x16x32_bf16 v[68:71], a[196:199], v[180:183], v[68:71]
    v_cvt_pk_bf16_f32 v206, v51, v59
    v_mfma_f32_16x16x32_bf16 v[76:79], a[196:199], v[176:179], v[76:79]
    v_cvt_pk_bf16_f32 v207, v83, v91
    v_mfma_f32_16x16x32_bf16 v[84:87], a[204:207], v[180:183], v[84:87]
    s_add_u32 s53, s51, 661504
    v_mfma_f32_16x16x32_bf16 v[92:95], a[204:207], v[176:179], v[92:95]
    buffer_store_dwordx2 v[206:207], v3, s[20:23], s53 offen offset:0 sc1
    v_cvt_pk_bf16_f32 v208, v36, v44
    s_nop 1
    v_cvt_pk_bf16_f32 v209, v68, v76
    s_add_u32 s53, s51, 0
    buffer_store_dwordx2 v[208:209], v3, s[20:23], s53 offen offset:128 sc1
    v_cvt_pk_bf16_f32 v210, v37, v45
    v_cvt_pk_bf16_f32 v211, v69, v77
    s_add_u32 s53, s51, 34816
    buffer_store_dwordx2 v[210:211], v3, s[20:23], s53 offen offset:128 sc1
    v_cvt_pk_bf16_f32 v236, v38, v46
    v_cvt_pk_bf16_f32 v237, v70, v78
    s_add_u32 s53, s51, 69632
    s_load_dword s96, s[20:21], s58 glc
    buffer_store_dwordx2 v[236:237], v3, s[20:23], s53 offen offset:128 sc1
    v_cvt_pk_bf16_f32 v238, v39, v47
    v_cvt_pk_bf16_f32 v239, v71, v79
    s_add_u32 s53, s51, 104448
    buffer_store_dwordx2 v[238:239], v3, s[20:23], s53 offen offset:128 sc1
    v_cvt_pk_bf16_f32 v204, v52, v60
    v_cvt_pk_bf16_f32 v205, v84, v92
    s_add_u32 s53, s51, 557056
    buffer_store_dwordx2 v[204:205], v3, s[20:23], s53 offen offset:128 sc1
    v_cvt_pk_bf16_f32 v206, v53, v61
    v_cvt_pk_bf16_f32 v207, v85, v93
    s_add_u32 s53, s51, 591872
    buffer_store_dwordx2 v[206:207], v3, s[20:23], s53 offen offset:128 sc1
    v_cvt_pk_bf16_f32 v208, v54, v62
    v_cvt_pk_bf16_f32 v209, v86, v94
    s_add_u32 s53, s51, 626688
    buffer_store_dwordx2 v[208:209], v3, s[20:23], s53 offen offset:128 sc1
    v_cvt_pk_bf16_f32 v210, v55, v63
    v_cvt_pk_bf16_f32 v211, v87, v95
    s_add_u32 s53, s51, 661504
    buffer_store_dwordx2 v[210:211], v3, s[20:23], s53 offen offset:128 sc1
    s_waitcnt lgkmcnt(0)
    s_cmp_lt_i32 s96, 3
    s_cbranch_scc0 dfl0_back
dfl0_spin:
    s_add_u32 s63, s63, 1
    s_cmp_gt_u32 s63, 0x40000
    s_cbranch_scc1 dfl0_back
    s_load_dword s96, s[20:21], s58 glc
    s_waitcnt lgkmcnt(0)
    s_cmp_lt_i32 s96, 3
    s_cbranch_scc1 dfl0_spin
dfl0_back:
    buffer_load_dwordx4 v[196:199], v12, s[8:11], s48 offen
    buffer_load_dwordx4 v[200:203], v12, s[8:11], s39 offen
    buffer_load_dwordx4 v[112:115], v9, s[20:23], s64 offen sc1
    buffer_load_dwordx4 v[116:119], v9, s[20:23], s65 offen sc1
    buffer_load_dwordx4 v[120:123], v8, s[20:23], s64 offen sc1
    buffer_load_dwordx4 v[124:127], v8, s[20:23], s65 offen sc1
    v_subrev_u32 v204, 98304, v22
    v_subrev_u32 v205, 98304, v23
    v_subrev_u32 v206, 98304, v24
    v_subrev_u32 v207, 98304, v25
    ds_read_b64_tr_b16 a[192:193], v204 offset:0
    ds_read_b64_tr_b16 a[194:195], v204 offset:2048
    ds_read_b64_tr_b16 a[196:197], v205 offset:0
    ds_read_b64_tr_b16 a[198:199], v205 offset:2048
    ds_read_b64_tr_b16 a[200:201], v206 offset:0
    ds_read_b64_tr_b16 a[202:203], v206 offset:2048
    ds_read_b64_tr_b16 a[204:205], v207 offset:0
    ds_read_b64_tr_b16 a[206:207], v207 offset:2048
    ds_read_b64_tr_b16 a[208:209], v204 offset:16384
    ds_read_b64_tr_b16 a[210:211], v204 offset:18432
    ds_read_b64_tr_b16 a[212:213], v205 offset:16384
    ds_read_b64_tr_b16 a[214:215], v205 offset:18432
    ds_read_b64_tr_b16 a[216:217], v206 offset:16384
    ds_read_b64_tr_b16 a[218:219], v206 offset:18432
    ds_read_b64_tr_b16 a[220:221], v207 offset:16384
    ds_read_b64_tr_b16 a[222:223], v207 offset:18432
    ds_read_b64_tr_b16 a[224:225], v204 offset:32768
    ds_read_b64_tr_b16 a[226:227], v204 offset:34816
    ds_read_b64_tr_b16 a[228:229], v205 offset:32768
    ds_read_b64_tr_b16 a[230:231], v205 offset:34816
    ds_read_b64_tr_b16 a[232:233], v206 offset:32768
    ds_read_b64_tr_b16 a[234:235], v206 offset:34816
    ds_read_b64_tr_b16 a[236:237], v207 offset:32768
    ds_read_b64_tr_b16 a[238:239], v207 offset:34816
    ds_read_b64_tr_b16 a[240:241], v204 offset:49152
    ds_read_b64_tr_b16 a[242:243], v204 offset:51200
    ds_read_b64_tr_b16 a[244:245], v205 offset:49152
    ds_read_b64_tr_b16 a[246:247], v205 offset:51200
    ds_read_b64_tr_b16 a[248:249], v206 offset:49152
    ds_read_b64_tr_b16 a[250:251], v206 offset:51200
    ds_read_b64_tr_b16 a[252:253], v207 offset:49152
    ds_read_b64_tr_b16 a[254:255], v207 offset:51200
k_padD:
    s_mov_b64 vcc, 1
    s_mov_b64 exec, 0
    s_cmp_eq_u32 s38, 0
    s_cbranch_scc1 k_pad0
    s_cmp_eq_u32 s38, 1
    s_cbranch_scc1 k_pad8
    s_cmp_eq_u32 s38, 2
    s_cbranch_scc1 k_padbackD
    s_branch k_padbackD
k_padbackD:
    s_mov_b64 exec, -1
    buffer_load_dwordx4 v[128:131], v9, s[20:23], s66 offen sc1
    buffer_load_dwordx4 v[132:135], v9, s[20:23], s67 offen sc1
    buffer_load_dwordx4 v[136:139], v8, s[20:23], s66 offen sc1
    buffer_load_dwordx4 v[140:143], v8, s[20:23], s67 offen sc1
    s_waitcnt vmcnt(10) lgkmcnt(0)
    s_barrier
    s_mov_b32 s97, 1
    s_cmp_lg_u32 s60, 0
    s_cbranch_scc1 k_nf3
    s_atomic_add s97, s[32:33], s47
k_nf3:
    buffer_load_dwordx4 v[144:147], v9, s[20:23], s68 offen sc1
    buffer_load_dwordx4 v[148:151], v9, s[20:23], s69 offen sc1
    buffer_load_dwordx4 v[152:155], v8, s[20:23], s68 offen sc1
    buffer_load_dwordx4 v[156:159], v8, s[20:23], s69 offen sc1
    s_branch k_p2
k_slow:
frdy_slow:
k_pad3:
    s_cbranch_execz k_padback
    s_nop 0
frdy_spin:
    s_add_u32 s63, s63, 1
    s_cmp_gt_u32 s63, 0x40000
    s_cbranch_scc1 frdy_back
    buffer_load_dword v30, off, s[32:35], 0 sc1
    s_waitcnt vmcnt(0)
    v_cmp_gt_i32 vcc, 8, v30
    s_cbranch_vccz frdy_back
    s_sleep 3
    s_branch frdy_spin
fg_spin:
    s_add_u32 s63, s63, 1
    s_cmp_gt_u32 s63, 0x40000
    s_cbranch_scc1 fg_back
    s_sleep 3
    s_mov_b32 s4, m0
    s_add_u32 m0, s43, 147456
    s_nop 0
    buffer_load_dwordx4 v26, s[20:23], s62 offen offset:0 sc1 lds
    buffer_load_dwordx4 v26, s[20:23], s62 offen offset:1024 sc1 lds
    buffer_load_dwordx4 v[192:195], v28, s[20:23], s61 offen offset:0 sc1
    s_mov_b32 m0, s4
    s_waitcnt vmcnt(0)
    ds_read_b128 v[244:247], v7 offset:0
    ds_read_b128 v[248:251], v7 offset:1024
    s_waitcnt lgkmcnt(0)
    s_waitcnt vmcnt(0)
    v_max3_u32 v30, v195, v194, v193
    v_max3_u32 v30, v30, v192, v251
    v_max3_u32 v30, v30, v250, v249
    v_max3_u32 v30, v30, v248, v247
    v_max3_u32 v30, v30, v246, v245
    v_max_u32 v30, v30, v244
    v_cmp_eq_u32 vcc, -1, v30
    s_cbranch_vccnz fg_spin
    s_branch fg_back
drdy_slow:
drdy_spin:
    s_add_u32 s63, s63, 1
    s_cmp_gt_u32 s63, 0x40000
    s_cbranch_scc1 drdy_back
    buffer_load_dword v30, off, s[32:35], 0 sc1
    s_waitcnt vmcnt(0)
    v_cmp_gt_i32 vcc, 8, v30
    s_cbranch_vccz drdy_back
    s_sleep 3
    s_branch drdy_spin
dg_spin:
    s_add_u32 s63, s63, 1
    s_cmp_gt_u32 s63, 0x40000
    s_cbranch_scc1 dg_back
    s_sleep 3
    buffer_load_dwordx4 v[192:195], v5, s[20:23], s62 offen offset:0 sc1
    buffer_load_dwordx4 v[196:199], v5, s[20:23], s62 offen offset:1024 sc1
    buffer_load_dwordx4 v[232:235], v28, s[20:23], s61 offen offset:0 sc1
    buffer_load_dword v200, v29, s[20:23], s62 offen offset:12 sc1
    s_waitcnt vmcnt(0)
    v_max3_u32 v30, v235, v234, v233
    v_max3_u32 v30, v30, v232, v200
    v_max3_u32 v30, v30, v199, v198
    v_max3_u32 v30, v30, v197, v196
    v_max3_u32 v30, v30, v195, v194
    v_max3_u32 v30, v30, v193, v192
    v_cmp_eq_u32 vcc, -1, v30
    s_cbranch_vccnz dg_spin
    s_branch dg_back
k_padret:
    s_cbranch_vccnz k_padbackD
    s_branch k_padbackB
fl1_slow:
k_pad2:
    s_cbranch_execz k_padret
    s_nop 0
    s_load_dword s96, s[20:21], s59 glc
    s_waitcnt lgkmcnt(0)
    s_cmp_lt_i32 s96, 3
    s_cbranch_scc0 fl1_back
    s_load_dword s96, s[20:21], s59 glc
    s_waitcnt lgkmcnt(0)
    s_cmp_lt_i32 s96, 3
    s_cbranch_scc0 fl1_back
    s_load_dword s96, s[20:21], s59 glc
    s_waitcnt lgkmcnt(0)
    s_cmp_lt_i32 s96, 3
    s_cbranch_scc0 fl1_back
    s_load_dword s96, s[20:21], s59 glc
    s_waitcnt lgkmcnt(0)
    s_cmp_lt_i32 s96, 3
    s_cbranch_scc0 fl1_back
    s_load_dword s96, s[20:21], s59 glc
    s_waitcnt lgkmcnt(0)
    s_cmp_lt_i32 s96, 3
    s_cbranch_scc0 fl1_back
    s_load_dword s96, s[20:21], s59 glc
    s_waitcnt lgkmcnt(0)
    s_cmp_lt_i32 s96, 3
    s_cbranch_scc0 fl1_back
fl1_spin:
    s_add_u32 s63, s63, 1
    s_cmp_gt_u32 s63, 0x40000
    s_cbranch_scc1 fl1_back
    buffer_load_dword v30, off, s[20:23], s59 sc1
    s_waitcnt vmcnt(0)
    v_cmp_gt_i32 vcc, 3, v30
    s_cbranch_vccz fl1_back
    s_sleep 1
    s_branch fl1_spin
zf_slow:
    v_and_b32 v7, 1, v0
    v_lshlrev_b32 v7, 6, v7
zf_spin:
    s_add_u32 s63, s63, 1
    s_cmp_gt_u32 s63, 0x40000
    s_cbranch_scc1 zf_back
    buffer_load_dword v30, v7, s[32:35], 0 offen offset:64 sc1
    s_waitcnt vmcnt(0)
    v_cmp_gt_i32 vcc, 16, v30
    s_cbranch_vccz zf_back
    s_sleep 6
    s_branch zf_spin
k_last:
    s_endpgm
    .fill (k_pc + 49152 - k_last)/4, 4, 0xbf810000
.section .rodata,"a"
.p2align 6
.amdhsa_kernel recurrent_scan__spectral_fnet__swiglu_ffn__prompt_kernel
  .amdhsa_next_free_vgpr 512
  .amdhsa_next_free_sgpr 102
  .amdhsa_accum_offset 256
  .amdhsa_group_segment_fixed_size 0
  .amdhsa_kernarg_size 96
  .amdhsa_user_sgpr_count 2
  .amdhsa_user_sgpr_kernarg_segment_ptr 1
  .amdhsa_system_sgpr_workgroup_id_x 1
.end_amdhsa_kernel
```
